```python
import torch

def _softmax(x, axis=-1):
    return torch.softmax(x, dim=axis)
def _gelu(x):
    return torch.nn.functional.gelu(x, approximate="tanh")
def _silu(x):
    return torch.nn.functional.silu(x)
def _sigmoid(x):
    return torch.sigmoid(x)
def _layernorm(x, axis=-1, eps=1e-5):
    m = x.mean(dim=axis, keepdim=True)
    v = x.var(dim=axis, keepdim=True, unbiased=False)
    return (x - m) / torch.sqrt(v + eps)
def _scatter_add(tgt, idx, src, axis=0):
    return tgt.clone().index_add_(axis, idx, src)
def _segment_sum(src, seg, n):
    out = torch.zeros((n,) + src.shape[1:], dtype=src.dtype)
    return out.index_add_(0, seg, src)
def _pad(x, pw):
    flat = tuple(v for pair in reversed(pw) for v in pair)
    return torch.nn.functional.pad(x, flat)

kernel_name = 'sequential_preLN__mha_block_cached__glu_gated_glu__decode'

def setup_inputs():

    _w = (lambda a: (lambda t: t.to(torch.bfloat16) if t.is_floating_point() else t)(torch.as_tensor(a)))
    def _A_setup():
        B, Sq, D = 4, 1, 512
        H, Sk, Dh = 32, 8192, 128
        return {
            "x": _w((lambda *s: torch.randn(*s, dtype=torch.bfloat16) * 0.05)(B, Sq, D)),
            "k_cache": _w((lambda *s: torch.randn(*s, dtype=torch.bfloat16) * 3.2)(B, H, Sk, Dh)),
            "v_cache": _w((lambda *s: torch.randn(*s, dtype=torch.bfloat16) * 0.4)(B, H, Sk, Dh)),
            "wq": _w((lambda *s: torch.randn(*s, dtype=torch.bfloat16) * 3.2)(D, H * Dh) * (D ** -0.5)),
            "wo": _w((lambda *s: torch.randn(*s, dtype=torch.bfloat16) * 0.4)(H * Dh, D) * ((H * Dh) ** -0.5)),
        }
    _A_in = _A_setup()

    def _B_setup():
        B, S, D, F = 4, 1, 512, 1792
        return {
            "x": _w((lambda *s: torch.randn(*s, dtype=torch.bfloat16) * 0.05)(B, S, D)),
            "w_gate": _w((lambda *s: torch.randn(*s, dtype=torch.bfloat16) * 0.1)(D, F)),
            "w_up": _w((lambda *s: torch.randn(*s, dtype=torch.bfloat16) * 0.05)(D, F)),
            "w_down": _w((lambda *s: torch.randn(*s, dtype=torch.bfloat16) * 0.05)(F, D)),
        }
    _B_in = _B_setup()

    return {
        "A_x": _A_in["x"],
        "A_k_cache": _A_in["k_cache"],
        "A_v_cache": _A_in["v_cache"],
        "A_wq": _A_in["wq"],
        "A_wo": _A_in["wo"],
        "B_x": _B_in["x"],
        "B_w_gate": _B_in["w_gate"],
        "B_w_up": _B_in["w_up"],
        "B_w_down": _B_in["w_down"],
    }

def reference(A_x, A_k_cache, A_v_cache, A_wq, A_wo, B_x, B_w_gate, B_w_up, B_w_down):
    def _A_ref(x, k_cache, v_cache, wq, wo):
        B, Sq, D = x.shape
        H, Dh = 32, 128
        q = (lambda x, *d: x.permute(*d))((x @ wq).reshape(B, Sq, H, Dh), 0, 2, 1, 3)
        scores = torch.einsum("bhqd,bhkd->bhqk", q, k_cache) * (Dh ** -0.5)
        p = _softmax(scores, axis=-1)
        o = torch.einsum("bhqk,bhkd->bhqd", p, v_cache)
        return (lambda x, *d: x.permute(*d))(o, 0, 2, 1, 3).reshape(B, Sq, H * Dh) @ wo

    def _B_ref(x, w_gate, w_up, w_down):
        g = torch.einsum("bsd,df->bsf", x, w_gate)
        u = torch.einsum("bsd,df->bsf", x, w_up)
        h = _sigmoid(g) * u
        return torch.einsum("bsf,fd->bsd", h, w_down)

    x = A_x
    h = x + _A_ref(_layernorm(x, axis=-1), A_k_cache, A_v_cache, A_wq, A_wo)
    h2 = h + _B_ref(_layernorm(h, axis=-1), B_w_gate, B_w_up, B_w_down)
    return h2
```

```asm
; @launch grid=(256,1,1) block=(512,1,1) lds=126144
.amdgcn_target "amdgcn-amd-amdhsa--gfx950"
.text
.globl sequential_preLN__mha_block_cached__glu_gated_glu__decode_kernel
.p2align 8
.type sequential_preLN__mha_block_cached__glu_gated_glu__decode_kernel,@function
sequential_preLN__mha_block_cached__glu_gated_glu__decode_kernel:
s_cmp_ge_u32 s2, 256
s_cbranch_scc1 L_end
s_load_dwordx4 s[4:7], s[0:1], 8
s_load_dwordx4 s[44:47], s[0:1], 80
s_load_dwordx2 s[20:21], s[0:1], 0
s_load_dwordx4 s[24:27], s[0:1], 24
s_load_dwordx4 s[28:31], s[0:1], 48
s_load_dwordx4 s[32:35], s[0:1], 64
v_and_b32 v1, 63, v0
v_lshrrev_b32 v2, 6, v0
v_lshlrev_b32 v1, 4, v1
v_readfirstlane_b32 s3, v2
s_mov_b32 s36, 0xaaaaaaaa
s_mov_b32 s37, 0xaaaaaaaa
s_mov_b32 s38, 0xcccccccc
s_mov_b32 s39, 0xcccccccc
s_lshr_b32 s40, s2, 1
s_xor_b32 s41, s40, s2
s_and_b32 s41, s41, 1
s_and_b32 s48, s40, 1
s_bfe_u32 s40, s2, 0x10002
s_lshl_b32 s40, s40, 1
s_or_b32 s77, s41, s40
s_lshr_b32 s51, s2, 3
s_lshl_b32 s51, s51, 2
s_add_u32 s51, s51, s77
s_and_b32 s49, s51, 31
s_lshr_b32 s50, s2, 6
v_bfe_u32 v2, v0, 4, 2
v_and_b32 v3, 15, v0
s_cmp_ge_u32 s3, 4
s_cbranch_scc1 L_helper
s_lshl_b32 s54, s51, 21
s_sub_u32 s40, 127, s3
s_cmp_eq_u32 s48, 0
s_cselect_b32 s40, s3, s40
s_lshr_b32 s41, s40, 2
s_lshl_b32 s41, s41, 16
s_and_b32 s42, s40, 3
s_lshl_b32 s42, s42, 12
s_add_u32 s52, s54, s41
s_add_u32 s52, s52, s42
s_mov_b32 s57, s52
s_mov_b32 s53, 0x10000
s_cmp_eq_u32 s48, 0
s_cselect_b32 s53, s53, 0xffff0000
s_cselect_b32 s55, 1, 0x10000
s_cselect_b32 s56, 0, 16
s_waitcnt lgkmcnt(0)
s_mov_b32 s8, s6
s_mov_b32 s9, s7
s_mov_b32 s6, 0x10000000
s_mov_b32 s7, 0x20000
s_mov_b32 s12, s46
s_mov_b32 s13, s47
s_mov_b32 s14, 0x40000000
s_mov_b32 s15, 0x20000
s_barrier
s_add_u32 s22, s52, 0
buffer_load_dwordx4 v[128:131], v1, s[4:7], s22 offen offset:0 nt
buffer_load_dwordx4 v[132:135], v1, s[4:7], s22 offen offset:1024 nt
buffer_load_dwordx4 v[136:139], v1, s[4:7], s22 offen offset:2048 nt
buffer_load_dwordx4 v[140:143], v1, s[4:7], s22 offen offset:3072 nt
s_add_u32 s22, s52, 16384
buffer_load_dwordx4 v[144:147], v1, s[4:7], s22 offen offset:0 nt
buffer_load_dwordx4 v[148:151], v1, s[4:7], s22 offen offset:1024 nt
buffer_load_dwordx4 v[152:155], v1, s[4:7], s22 offen offset:2048 nt
buffer_load_dwordx4 v[156:159], v1, s[4:7], s22 offen offset:3072 nt
s_add_u32 s22, s52, 32768
buffer_load_dwordx4 v[160:163], v1, s[4:7], s22 offen offset:0 nt
buffer_load_dwordx4 v[164:167], v1, s[4:7], s22 offen offset:1024 nt
buffer_load_dwordx4 v[168:171], v1, s[4:7], s22 offen offset:2048 nt
buffer_load_dwordx4 v[172:175], v1, s[4:7], s22 offen offset:3072 nt
s_add_u32 s22, s52, 49152
buffer_load_dwordx4 v[176:179], v1, s[4:7], s22 offen offset:0 nt
buffer_load_dwordx4 v[180:183], v1, s[4:7], s22 offen offset:1024 nt
buffer_load_dwordx4 v[184:187], v1, s[4:7], s22 offen offset:2048 nt
buffer_load_dwordx4 v[188:191], v1, s[4:7], s22 offen offset:3072 nt
s_add_u32 s52, s52, s53
s_add_u32 s22, s52, 0
buffer_load_dwordx4 v[192:195], v1, s[4:7], s22 offen offset:0 nt
buffer_load_dwordx4 v[196:199], v1, s[4:7], s22 offen offset:1024 nt
buffer_load_dwordx4 v[200:203], v1, s[4:7], s22 offen offset:2048 nt
buffer_load_dwordx4 v[204:207], v1, s[4:7], s22 offen offset:3072 nt
s_add_u32 s22, s52, 16384
buffer_load_dwordx4 v[208:211], v1, s[4:7], s22 offen offset:0 nt
buffer_load_dwordx4 v[212:215], v1, s[4:7], s22 offen offset:1024 nt
buffer_load_dwordx4 v[216:219], v1, s[4:7], s22 offen offset:2048 nt
buffer_load_dwordx4 v[220:223], v1, s[4:7], s22 offen offset:3072 nt
s_add_u32 s22, s52, 32768
buffer_load_dwordx4 v[224:227], v1, s[4:7], s22 offen offset:0 nt
buffer_load_dwordx4 v[228:231], v1, s[4:7], s22 offen offset:1024 nt
buffer_load_dwordx4 v[232:235], v1, s[4:7], s22 offen offset:2048 nt
buffer_load_dwordx4 v[236:239], v1, s[4:7], s22 offen offset:3072 nt
s_add_u32 s22, s52, 49152
buffer_load_dwordx4 v[240:243], v1, s[4:7], s22 offen offset:0 nt
buffer_load_dwordx4 v[244:247], v1, s[4:7], s22 offen offset:1024 nt
buffer_load_dwordx4 v[248:251], v1, s[4:7], s22 offen offset:2048 nt
buffer_load_dwordx4 v[252:255], v1, s[4:7], s22 offen offset:3072 nt
s_add_u32 s52, s52, s53
s_add_u32 s22, s52, 0
buffer_load_dwordx4 v[64:67], v1, s[4:7], s22 offen offset:0 nt
buffer_load_dwordx4 v[68:71], v1, s[4:7], s22 offen offset:1024 nt
buffer_load_dwordx4 v[72:75], v1, s[4:7], s22 offen offset:2048 nt
buffer_load_dwordx4 v[76:79], v1, s[4:7], s22 offen offset:3072 nt
s_add_u32 s22, s52, 16384
buffer_load_dwordx4 v[80:83], v1, s[4:7], s22 offen offset:0 nt
buffer_load_dwordx4 v[84:87], v1, s[4:7], s22 offen offset:1024 nt
buffer_load_dwordx4 v[88:91], v1, s[4:7], s22 offen offset:2048 nt
buffer_load_dwordx4 v[92:95], v1, s[4:7], s22 offen offset:3072 nt
s_add_u32 s22, s52, 32768
buffer_load_dwordx4 v[96:99], v1, s[4:7], s22 offen offset:0 nt
buffer_load_dwordx4 v[100:103], v1, s[4:7], s22 offen offset:1024 nt
buffer_load_dwordx4 v[104:107], v1, s[4:7], s22 offen offset:2048 nt
buffer_load_dwordx4 v[108:111], v1, s[4:7], s22 offen offset:3072 nt
s_add_u32 s22, s52, 49152
buffer_load_dwordx4 v[112:115], v1, s[4:7], s22 offen offset:0 nt
buffer_load_dwordx4 v[116:119], v1, s[4:7], s22 offen offset:1024 nt
buffer_load_dwordx4 v[120:123], v1, s[4:7], s22 offen offset:2048 nt
buffer_load_dwordx4 v[124:127], v1, s[4:7], s22 offen offset:3072 nt
s_add_u32 s52, s52, s53
v_mov_b32 v8, 0
v_mov_b32 v28, 0xffff
v_cmp_eq_u32 vcc, 0, v3
s_nop 1
v_cndmask_b32 v8, v8, v28, vcc
v_mov_b32 v28, 0xffff0000
v_cmp_eq_u32 vcc, 1, v3
s_nop 1
v_cndmask_b32 v8, v8, v28, vcc
v_mov_b32 v9, 0
v_mov_b32 v28, 0xffff
v_cmp_eq_u32 vcc, 2, v3
s_nop 1
v_cndmask_b32 v9, v9, v28, vcc
v_mov_b32 v28, 0xffff0000
v_cmp_eq_u32 vcc, 3, v3
s_nop 1
v_cndmask_b32 v9, v9, v28, vcc
v_mov_b32 v10, 0
v_mov_b32 v28, 0xffff
v_cmp_eq_u32 vcc, 4, v3
s_nop 1
v_cndmask_b32 v10, v10, v28, vcc
v_mov_b32 v28, 0xffff0000
v_cmp_eq_u32 vcc, 5, v3
s_nop 1
v_cndmask_b32 v10, v10, v28, vcc
v_mov_b32 v11, 0
v_mov_b32 v28, 0xffff
v_cmp_eq_u32 vcc, 6, v3
s_nop 1
v_cndmask_b32 v11, v11, v28, vcc
v_mov_b32 v28, 0xffff0000
v_cmp_eq_u32 vcc, 7, v3
s_nop 1
v_cndmask_b32 v11, v11, v28, vcc
v_mov_b32 v20, 0
v_mov_b32 v21, 0
v_mov_b32 v22, 0
v_mov_b32 v23, 0
v_mov_b32 v24, 0xff7fffff
v_mov_b32 v25, 0
v_lshlrev_b32 v26, 5, v3
v_mov_b32 v27, 14368
s_mov_b32 s65, 0
v_and_b32 v56, 7, v0
v_lshl_add_u32 v56, v2, 5, v56
v_bfe_u32 v29, v0, 3, 1
v_lshl_add_u32 v56, v29, 7, v56
v_lshlrev_b32 v56, 2, v56
s_lshl_b32 s40, s3, 10
v_add_u32 v56, s40, v56
s_lshl_b32 s40, s3, 3
v_mov_b32 v57, s40
ds_write_b32 v56, v20 offset:21632
ds_write_b32 v56, v20 offset:21664
ds_write_b32 v56, v20 offset:21696
ds_write_b32 v56, v20 offset:21728
ds_write_b64 v57, v[24:25] offset:25728
v_add_u32 v56, 10240, v56
v_add_u32 v57, 14336, v57
s_mov_b32 s87, 0
s_mov_b32 s88, 0xffff
s_mul_i32 s40, s3, 4608
v_lshrrev_b32 v60, 2, v1
v_add_u32 v58, s40, v60
v_mov_b32 v59, v58
s_lshl_b32 s40, s51, 8
s_add_u32 s40, s40, 2686976
s_add_u32 s74, s46, s40
s_addc_u32 s75, s47, 0
s_lshl_b32 s73, s51, 15
s_add_u32 s73, s73, 4194304
v_mov_b32 v61, 19584
s_barrier
ds_read_b64 v[28:29], v61
ds_read_b128 v[32:35], v26 offset:8192
ds_read_b128 v[36:39], v26 offset:8208
ds_read_b128 v[40:43], v26 offset:8704
ds_read_b128 v[44:47], v26 offset:8720
ds_read_b128 v[48:51], v26 offset:9216
ds_read_b128 v[52:55], v26 offset:9232
ds_read_b128 v[12:15], v26 offset:9728
ds_read_b128 v[16:19], v26 offset:9744
s_waitcnt lgkmcnt(0)
v_add_f32 v32, v32, v40
v_add_f32 v48, v48, v12
v_add_f32 v32, v32, v48
v_add_f32 v33, v33, v41
v_add_f32 v49, v49, v13
v_add_f32 v33, v33, v49
v_add_f32 v34, v34, v42
v_add_f32 v50, v50, v14
v_add_f32 v34, v34, v50
v_add_f32 v35, v35, v43
v_add_f32 v51, v51, v15
v_add_f32 v35, v35, v51
v_add_f32 v36, v36, v44
v_add_f32 v52, v52, v16
v_add_f32 v36, v36, v52
v_add_f32 v37, v37, v45
v_add_f32 v53, v53, v17
v_add_f32 v37, v37, v53
v_add_f32 v38, v38, v46
v_add_f32 v54, v54, v18
v_add_f32 v38, v38, v54
v_add_f32 v39, v39, v47
v_add_f32 v55, v55, v19
v_add_f32 v39, v39, v55
v_cvt_pk_bf16_f32 v4, v32, v33
v_cvt_pk_bf16_f32 v5, v34, v35
v_cvt_pk_bf16_f32 v6, v36, v37
v_cvt_pk_bf16_f32 v7, v38, v39
v_readfirstlane_b32 s71, v28
v_readfirstlane_b32 s70, v29
s_waitcnt vmcnt(47)
v_dot2_f32_bf16 v32, v128, v4, 0
v_dot2_f32_bf16 v32, v129, v5, v32
v_dot2_f32_bf16 v32, v130, v6, v32
v_dot2_f32_bf16 v32, v131, v7, v32
s_add_u32 s22, s52, 0
buffer_load_dwordx4 v[128:131], v1, s[4:7], s22 offen offset:0 nt
s_waitcnt vmcnt(47)
v_dot2_f32_bf16 v33, v132, v4, 0
v_dot2_f32_bf16 v33, v133, v5, v33
v_dot2_f32_bf16 v33, v134, v6, v33
v_dot2_f32_bf16 v33, v135, v7, v33
buffer_load_dwordx4 v[132:135], v1, s[4:7], s22 offen offset:1024 nt
s_waitcnt vmcnt(47)
v_dot2_f32_bf16 v34, v136, v4, 0
v_dot2_f32_bf16 v34, v137, v5, v34
v_dot2_f32_bf16 v34, v138, v6, v34
v_dot2_f32_bf16 v34, v139, v7, v34
buffer_load_dwordx4 v[136:139], v1, s[4:7], s22 offen offset:2048 nt
s_waitcnt vmcnt(47)
v_dot2_f32_bf16 v35, v140, v4, 0
v_dot2_f32_bf16 v35, v141, v5, v35
v_dot2_f32_bf16 v35, v142, v6, v35
v_dot2_f32_bf16 v35, v143, v7, v35
buffer_load_dwordx4 v[140:143], v1, s[4:7], s22 offen offset:3072 nt
s_waitcnt vmcnt(47)
v_dot2_f32_bf16 v36, v144, v4, 0
v_dot2_f32_bf16 v36, v145, v5, v36
v_dot2_f32_bf16 v36, v146, v6, v36
v_dot2_f32_bf16 v36, v147, v7, v36
s_add_u32 s22, s52, 16384
buffer_load_dwordx4 v[144:147], v1, s[4:7], s22 offen offset:0 nt
s_waitcnt vmcnt(47)
v_dot2_f32_bf16 v37, v148, v4, 0
v_dot2_f32_bf16 v37, v149, v5, v37
v_dot2_f32_bf16 v37, v150, v6, v37
v_dot2_f32_bf16 v37, v151, v7, v37
buffer_load_dwordx4 v[148:151], v1, s[4:7], s22 offen offset:1024 nt
s_waitcnt vmcnt(47)
v_dot2_f32_bf16 v38, v152, v4, 0
v_dot2_f32_bf16 v38, v153, v5, v38
v_dot2_f32_bf16 v38, v154, v6, v38
v_dot2_f32_bf16 v38, v155, v7, v38
buffer_load_dwordx4 v[152:155], v1, s[4:7], s22 offen offset:2048 nt
s_waitcnt vmcnt(47)
v_dot2_f32_bf16 v39, v156, v4, 0
v_dot2_f32_bf16 v39, v157, v5, v39
v_dot2_f32_bf16 v39, v158, v6, v39
v_dot2_f32_bf16 v39, v159, v7, v39
buffer_load_dwordx4 v[156:159], v1, s[4:7], s22 offen offset:3072 nt
s_waitcnt vmcnt(47)
v_dot2_f32_bf16 v40, v160, v4, 0
v_dot2_f32_bf16 v40, v161, v5, v40
v_dot2_f32_bf16 v40, v162, v6, v40
v_dot2_f32_bf16 v40, v163, v7, v40
s_add_u32 s22, s52, 32768
buffer_load_dwordx4 v[160:163], v1, s[4:7], s22 offen offset:0 nt
s_waitcnt vmcnt(47)
v_dot2_f32_bf16 v41, v164, v4, 0
v_dot2_f32_bf16 v41, v165, v5, v41
v_dot2_f32_bf16 v41, v166, v6, v41
v_dot2_f32_bf16 v41, v167, v7, v41
buffer_load_dwordx4 v[164:167], v1, s[4:7], s22 offen offset:1024 nt
s_waitcnt vmcnt(47)
v_dot2_f32_bf16 v42, v168, v4, 0
v_dot2_f32_bf16 v42, v169, v5, v42
v_dot2_f32_bf16 v42, v170, v6, v42
v_dot2_f32_bf16 v42, v171, v7, v42
buffer_load_dwordx4 v[168:171], v1, s[4:7], s22 offen offset:2048 nt
s_waitcnt vmcnt(47)
v_dot2_f32_bf16 v43, v172, v4, 0
v_dot2_f32_bf16 v43, v173, v5, v43
v_dot2_f32_bf16 v43, v174, v6, v43
v_dot2_f32_bf16 v43, v175, v7, v43
buffer_load_dwordx4 v[172:175], v1, s[4:7], s22 offen offset:3072 nt
s_waitcnt vmcnt(47)
v_dot2_f32_bf16 v44, v176, v4, 0
v_dot2_f32_bf16 v44, v177, v5, v44
v_dot2_f32_bf16 v44, v178, v6, v44
v_dot2_f32_bf16 v44, v179, v7, v44
s_add_u32 s22, s52, 49152
buffer_load_dwordx4 v[176:179], v1, s[4:7], s22 offen offset:0 nt
s_waitcnt vmcnt(47)
v_dot2_f32_bf16 v45, v180, v4, 0
v_dot2_f32_bf16 v45, v181, v5, v45
v_dot2_f32_bf16 v45, v182, v6, v45
v_dot2_f32_bf16 v45, v183, v7, v45
buffer_load_dwordx4 v[180:183], v1, s[4:7], s22 offen offset:1024 nt
s_waitcnt vmcnt(47)
v_dot2_f32_bf16 v46, v184, v4, 0
v_dot2_f32_bf16 v46, v185, v5, v46
v_dot2_f32_bf16 v46, v186, v6, v46
v_dot2_f32_bf16 v46, v187, v7, v46
buffer_load_dwordx4 v[184:187], v1, s[4:7], s22 offen offset:2048 nt
s_waitcnt vmcnt(47)
v_dot2_f32_bf16 v47, v188, v4, 0
v_dot2_f32_bf16 v47, v189, v5, v47
v_dot2_f32_bf16 v47, v190, v6, v47
v_dot2_f32_bf16 v47, v191, v7, v47
buffer_load_dwordx4 v[188:191], v1, s[4:7], s22 offen offset:3072 nt
v_add_f32_dpp v32, v32, v32 row_ror:8 row_mask:0xf bank_mask:0x3
v_add_f32_dpp v32, v40, v40 row_ror:8 row_mask:0xf bank_mask:0xc
v_add_f32_dpp v33, v33, v33 row_ror:8 row_mask:0xf bank_mask:0x3
v_add_f32_dpp v33, v41, v41 row_ror:8 row_mask:0xf bank_mask:0xc
v_add_f32_dpp v34, v34, v34 row_ror:8 row_mask:0xf bank_mask:0x3
v_add_f32_dpp v34, v42, v42 row_ror:8 row_mask:0xf bank_mask:0xc
v_add_f32_dpp v35, v35, v35 row_ror:8 row_mask:0xf bank_mask:0x3
v_add_f32_dpp v35, v43, v43 row_ror:8 row_mask:0xf bank_mask:0xc
v_add_f32_dpp v36, v36, v36 row_ror:8 row_mask:0xf bank_mask:0x3
v_add_f32_dpp v36, v44, v44 row_ror:8 row_mask:0xf bank_mask:0xc
v_add_f32_dpp v37, v37, v37 row_ror:8 row_mask:0xf bank_mask:0x3
v_add_f32_dpp v37, v45, v45 row_ror:8 row_mask:0xf bank_mask:0xc
v_add_f32_dpp v38, v38, v38 row_ror:8 row_mask:0xf bank_mask:0x3
v_add_f32_dpp v38, v46, v46 row_ror:8 row_mask:0xf bank_mask:0xc
v_add_f32_dpp v39, v39, v39 row_ror:8 row_mask:0xf bank_mask:0x3
v_add_f32_dpp v39, v47, v47 row_ror:8 row_mask:0xf bank_mask:0xc
v_add_f32_dpp v32, v32, v32 row_half_mirror row_mask:0xf bank_mask:0x5
v_add_f32_dpp v32, v36, v36 row_half_mirror row_mask:0xf bank_mask:0xa
v_add_f32_dpp v33, v33, v33 row_half_mirror row_mask:0xf bank_mask:0x5
v_add_f32_dpp v33, v37, v37 row_half_mirror row_mask:0xf bank_mask:0xa
v_add_f32_dpp v34, v34, v34 row_half_mirror row_mask:0xf bank_mask:0x5
v_add_f32_dpp v34, v38, v38 row_half_mirror row_mask:0xf bank_mask:0xa
v_add_f32_dpp v35, v35, v35 row_half_mirror row_mask:0xf bank_mask:0x5
v_add_f32_dpp v35, v39, v39 row_half_mirror row_mask:0xf bank_mask:0xa
v_cndmask_b32 v28, v33, v32, s[36:37]
v_cndmask_b32 v29, v32, v33, s[36:37]
v_cndmask_b32 v30, v35, v34, s[36:37]
v_cndmask_b32 v31, v34, v35, s[36:37]
v_add_f32_dpp v29, v28, v29 quad_perm:[1,0,3,2] row_mask:0xf bank_mask:0xf
v_add_f32_dpp v31, v30, v31 quad_perm:[1,0,3,2] row_mask:0xf bank_mask:0xf
v_cndmask_b32 v28, v31, v29, s[38:39]
v_cndmask_b32 v30, v29, v31, s[38:39]
s_nop 0
v_add_f32_dpp v30, v28, v30 quad_perm:[2,3,0,1] row_mask:0xf bank_mask:0xf
v_cvt_pk_bf16_f32 v30, v30, v30
v_lshlrev_b32 v30, 16, v30
v_mul_f32 v30, 0x3db504f3, v30
v_cvt_pk_bf16_f32 v30, v30, v30
v_lshlrev_b32 v30, 16, v30
v_max_f32 v24, v30, v24
ds_write_b32 v58, v30 offset:25792
v_add_u32 v58, 256, v58
s_add_u32 s65, s65, 1
v_mov_b32 v26, s65
ds_max_u32 v27, v26
s_waitcnt vmcnt(47)
v_dot2_f32_bf16 v32, v192, v4, 0
v_dot2_f32_bf16 v32, v193, v5, v32
v_dot2_f32_bf16 v32, v194, v6, v32
v_dot2_f32_bf16 v32, v195, v7, v32
s_waitcnt vmcnt(46)
v_dot2_f32_bf16 v33, v196, v4, 0
v_dot2_f32_bf16 v33, v197, v5, v33
v_dot2_f32_bf16 v33, v198, v6, v33
v_dot2_f32_bf16 v33, v199, v7, v33
s_waitcnt vmcnt(45)
v_dot2_f32_bf16 v34, v200, v4, 0
v_dot2_f32_bf16 v34, v201, v5, v34
v_dot2_f32_bf16 v34, v202, v6, v34
v_dot2_f32_bf16 v34, v203, v7, v34
s_waitcnt vmcnt(44)
v_dot2_f32_bf16 v35, v204, v4, 0
v_dot2_f32_bf16 v35, v205, v5, v35
v_dot2_f32_bf16 v35, v206, v6, v35
v_dot2_f32_bf16 v35, v207, v7, v35
s_waitcnt vmcnt(43)
v_dot2_f32_bf16 v36, v208, v4, 0
v_dot2_f32_bf16 v36, v209, v5, v36
v_dot2_f32_bf16 v36, v210, v6, v36
v_dot2_f32_bf16 v36, v211, v7, v36
s_waitcnt vmcnt(42)
v_dot2_f32_bf16 v37, v212, v4, 0
v_dot2_f32_bf16 v37, v213, v5, v37
v_dot2_f32_bf16 v37, v214, v6, v37
v_dot2_f32_bf16 v37, v215, v7, v37
s_waitcnt vmcnt(41)
v_dot2_f32_bf16 v38, v216, v4, 0
v_dot2_f32_bf16 v38, v217, v5, v38
v_dot2_f32_bf16 v38, v218, v6, v38
v_dot2_f32_bf16 v38, v219, v7, v38
s_waitcnt vmcnt(40)
v_dot2_f32_bf16 v39, v220, v4, 0
v_dot2_f32_bf16 v39, v221, v5, v39
v_dot2_f32_bf16 v39, v222, v6, v39
v_dot2_f32_bf16 v39, v223, v7, v39
s_waitcnt vmcnt(39)
v_dot2_f32_bf16 v40, v224, v4, 0
v_dot2_f32_bf16 v40, v225, v5, v40
v_dot2_f32_bf16 v40, v226, v6, v40
v_dot2_f32_bf16 v40, v227, v7, v40
s_waitcnt vmcnt(38)
v_dot2_f32_bf16 v41, v228, v4, 0
v_dot2_f32_bf16 v41, v229, v5, v41
v_dot2_f32_bf16 v41, v230, v6, v41
v_dot2_f32_bf16 v41, v231, v7, v41
s_waitcnt vmcnt(37)
v_dot2_f32_bf16 v42, v232, v4, 0
v_dot2_f32_bf16 v42, v233, v5, v42
v_dot2_f32_bf16 v42, v234, v6, v42
v_dot2_f32_bf16 v42, v235, v7, v42
s_waitcnt vmcnt(36)
v_dot2_f32_bf16 v43, v236, v4, 0
v_dot2_f32_bf16 v43, v237, v5, v43
v_dot2_f32_bf16 v43, v238, v6, v43
v_dot2_f32_bf16 v43, v239, v7, v43
s_waitcnt vmcnt(35)
v_dot2_f32_bf16 v44, v240, v4, 0
v_dot2_f32_bf16 v44, v241, v5, v44
v_dot2_f32_bf16 v44, v242, v6, v44
v_dot2_f32_bf16 v44, v243, v7, v44
s_waitcnt vmcnt(34)
v_dot2_f32_bf16 v45, v244, v4, 0
v_dot2_f32_bf16 v45, v245, v5, v45
v_dot2_f32_bf16 v45, v246, v6, v45
v_dot2_f32_bf16 v45, v247, v7, v45
s_waitcnt vmcnt(33)
v_dot2_f32_bf16 v46, v248, v4, 0
v_dot2_f32_bf16 v46, v249, v5, v46
v_dot2_f32_bf16 v46, v250, v6, v46
v_dot2_f32_bf16 v46, v251, v7, v46
s_waitcnt vmcnt(32)
v_dot2_f32_bf16 v47, v252, v4, 0
v_dot2_f32_bf16 v47, v253, v5, v47
v_dot2_f32_bf16 v47, v254, v6, v47
v_dot2_f32_bf16 v47, v255, v7, v47
v_add_f32_dpp v32, v32, v32 row_ror:8 row_mask:0xf bank_mask:0x3
v_add_f32_dpp v32, v40, v40 row_ror:8 row_mask:0xf bank_mask:0xc
v_add_f32_dpp v33, v33, v33 row_ror:8 row_mask:0xf bank_mask:0x3
v_add_f32_dpp v33, v41, v41 row_ror:8 row_mask:0xf bank_mask:0xc
v_add_f32_dpp v34, v34, v34 row_ror:8 row_mask:0xf bank_mask:0x3
v_add_f32_dpp v34, v42, v42 row_ror:8 row_mask:0xf bank_mask:0xc
v_add_f32_dpp v35, v35, v35 row_ror:8 row_mask:0xf bank_mask:0x3
v_add_f32_dpp v35, v43, v43 row_ror:8 row_mask:0xf bank_mask:0xc
v_add_f32_dpp v36, v36, v36 row_ror:8 row_mask:0xf bank_mask:0x3
v_add_f32_dpp v36, v44, v44 row_ror:8 row_mask:0xf bank_mask:0xc
v_add_f32_dpp v37, v37, v37 row_ror:8 row_mask:0xf bank_mask:0x3
v_add_f32_dpp v37, v45, v45 row_ror:8 row_mask:0xf bank_mask:0xc
v_add_f32_dpp v38, v38, v38 row_ror:8 row_mask:0xf bank_mask:0x3
v_add_f32_dpp v38, v46, v46 row_ror:8 row_mask:0xf bank_mask:0xc
v_add_f32_dpp v39, v39, v39 row_ror:8 row_mask:0xf bank_mask:0x3
v_add_f32_dpp v39, v47, v47 row_ror:8 row_mask:0xf bank_mask:0xc
v_add_f32_dpp v32, v32, v32 row_half_mirror row_mask:0xf bank_mask:0x5
v_add_f32_dpp v32, v36, v36 row_half_mirror row_mask:0xf bank_mask:0xa
v_add_f32_dpp v33, v33, v33 row_half_mirror row_mask:0xf bank_mask:0x5
v_add_f32_dpp v33, v37, v37 row_half_mirror row_mask:0xf bank_mask:0xa
v_add_f32_dpp v34, v34, v34 row_half_mirror row_mask:0xf bank_mask:0x5
v_add_f32_dpp v34, v38, v38 row_half_mirror row_mask:0xf bank_mask:0xa
v_add_f32_dpp v35, v35, v35 row_half_mirror row_mask:0xf bank_mask:0x5
v_add_f32_dpp v35, v39, v39 row_half_mirror row_mask:0xf bank_mask:0xa
v_cndmask_b32 v28, v33, v32, s[36:37]
v_cndmask_b32 v29, v32, v33, s[36:37]
v_cndmask_b32 v30, v35, v34, s[36:37]
v_cndmask_b32 v31, v34, v35, s[36:37]
v_add_f32_dpp v29, v28, v29 quad_perm:[1,0,3,2] row_mask:0xf bank_mask:0xf
v_add_f32_dpp v31, v30, v31 quad_perm:[1,0,3,2] row_mask:0xf bank_mask:0xf
v_cndmask_b32 v28, v31, v29, s[38:39]
v_cndmask_b32 v30, v29, v31, s[38:39]
s_nop 0
v_add_f32_dpp v30, v28, v30 quad_perm:[2,3,0,1] row_mask:0xf bank_mask:0xf
v_cvt_pk_bf16_f32 v30, v30, v30
v_lshlrev_b32 v30, 16, v30
v_mul_f32 v30, 0x3db504f3, v30
v_cvt_pk_bf16_f32 v30, v30, v30
v_lshlrev_b32 v30, 16, v30
v_max_f32 v24, v30, v24
ds_write_b32 v58, v30 offset:25792
v_add_u32 v58, 256, v58
s_add_u32 s65, s65, 1
v_mov_b32 v26, s65
ds_max_u32 v27, v26
s_waitcnt vmcnt(31)
v_dot2_f32_bf16 v32, v64, v4, 0
v_dot2_f32_bf16 v32, v65, v5, v32
v_dot2_f32_bf16 v32, v66, v6, v32
v_dot2_f32_bf16 v32, v67, v7, v32
s_waitcnt vmcnt(30)
v_dot2_f32_bf16 v33, v68, v4, 0
v_dot2_f32_bf16 v33, v69, v5, v33
v_dot2_f32_bf16 v33, v70, v6, v33
v_dot2_f32_bf16 v33, v71, v7, v33
s_waitcnt vmcnt(29)
v_dot2_f32_bf16 v34, v72, v4, 0
v_dot2_f32_bf16 v34, v73, v5, v34
v_dot2_f32_bf16 v34, v74, v6, v34
v_dot2_f32_bf16 v34, v75, v7, v34
s_waitcnt vmcnt(28)
v_dot2_f32_bf16 v35, v76, v4, 0
v_dot2_f32_bf16 v35, v77, v5, v35
v_dot2_f32_bf16 v35, v78, v6, v35
v_dot2_f32_bf16 v35, v79, v7, v35
s_waitcnt vmcnt(27)
v_dot2_f32_bf16 v36, v80, v4, 0
v_dot2_f32_bf16 v36, v81, v5, v36
v_dot2_f32_bf16 v36, v82, v6, v36
v_dot2_f32_bf16 v36, v83, v7, v36
s_waitcnt vmcnt(26)
v_dot2_f32_bf16 v37, v84, v4, 0
v_dot2_f32_bf16 v37, v85, v5, v37
v_dot2_f32_bf16 v37, v86, v6, v37
v_dot2_f32_bf16 v37, v87, v7, v37
s_waitcnt vmcnt(25)
v_dot2_f32_bf16 v38, v88, v4, 0
v_dot2_f32_bf16 v38, v89, v5, v38
v_dot2_f32_bf16 v38, v90, v6, v38
v_dot2_f32_bf16 v38, v91, v7, v38
s_waitcnt vmcnt(24)
v_dot2_f32_bf16 v39, v92, v4, 0
v_dot2_f32_bf16 v39, v93, v5, v39
v_dot2_f32_bf16 v39, v94, v6, v39
v_dot2_f32_bf16 v39, v95, v7, v39
s_waitcnt vmcnt(23)
v_dot2_f32_bf16 v40, v96, v4, 0
v_dot2_f32_bf16 v40, v97, v5, v40
v_dot2_f32_bf16 v40, v98, v6, v40
v_dot2_f32_bf16 v40, v99, v7, v40
s_waitcnt vmcnt(22)
v_dot2_f32_bf16 v41, v100, v4, 0
v_dot2_f32_bf16 v41, v101, v5, v41
v_dot2_f32_bf16 v41, v102, v6, v41
v_dot2_f32_bf16 v41, v103, v7, v41
s_waitcnt vmcnt(21)
v_dot2_f32_bf16 v42, v104, v4, 0
v_dot2_f32_bf16 v42, v105, v5, v42
v_dot2_f32_bf16 v42, v106, v6, v42
v_dot2_f32_bf16 v42, v107, v7, v42
s_waitcnt vmcnt(20)
v_dot2_f32_bf16 v43, v108, v4, 0
v_dot2_f32_bf16 v43, v109, v5, v43
v_dot2_f32_bf16 v43, v110, v6, v43
v_dot2_f32_bf16 v43, v111, v7, v43
s_waitcnt vmcnt(19)
v_dot2_f32_bf16 v44, v112, v4, 0
v_dot2_f32_bf16 v44, v113, v5, v44
v_dot2_f32_bf16 v44, v114, v6, v44
v_dot2_f32_bf16 v44, v115, v7, v44
s_waitcnt vmcnt(18)
v_dot2_f32_bf16 v45, v116, v4, 0
v_dot2_f32_bf16 v45, v117, v5, v45
v_dot2_f32_bf16 v45, v118, v6, v45
v_dot2_f32_bf16 v45, v119, v7, v45
s_waitcnt vmcnt(17)
v_dot2_f32_bf16 v46, v120, v4, 0
v_dot2_f32_bf16 v46, v121, v5, v46
v_dot2_f32_bf16 v46, v122, v6, v46
v_dot2_f32_bf16 v46, v123, v7, v46
s_waitcnt vmcnt(16)
v_dot2_f32_bf16 v47, v124, v4, 0
v_dot2_f32_bf16 v47, v125, v5, v47
v_dot2_f32_bf16 v47, v126, v6, v47
v_dot2_f32_bf16 v47, v127, v7, v47
v_add_f32_dpp v32, v32, v32 row_ror:8 row_mask:0xf bank_mask:0x3
v_add_f32_dpp v32, v40, v40 row_ror:8 row_mask:0xf bank_mask:0xc
v_add_f32_dpp v33, v33, v33 row_ror:8 row_mask:0xf bank_mask:0x3
v_add_f32_dpp v33, v41, v41 row_ror:8 row_mask:0xf bank_mask:0xc
v_add_f32_dpp v34, v34, v34 row_ror:8 row_mask:0xf bank_mask:0x3
v_add_f32_dpp v34, v42, v42 row_ror:8 row_mask:0xf bank_mask:0xc
v_add_f32_dpp v35, v35, v35 row_ror:8 row_mask:0xf bank_mask:0x3
v_add_f32_dpp v35, v43, v43 row_ror:8 row_mask:0xf bank_mask:0xc
v_add_f32_dpp v36, v36, v36 row_ror:8 row_mask:0xf bank_mask:0x3
v_add_f32_dpp v36, v44, v44 row_ror:8 row_mask:0xf bank_mask:0xc
v_add_f32_dpp v37, v37, v37 row_ror:8 row_mask:0xf bank_mask:0x3
v_add_f32_dpp v37, v45, v45 row_ror:8 row_mask:0xf bank_mask:0xc
v_add_f32_dpp v38, v38, v38 row_ror:8 row_mask:0xf bank_mask:0x3
v_add_f32_dpp v38, v46, v46 row_ror:8 row_mask:0xf bank_mask:0xc
v_add_f32_dpp v39, v39, v39 row_ror:8 row_mask:0xf bank_mask:0x3
v_add_f32_dpp v39, v47, v47 row_ror:8 row_mask:0xf bank_mask:0xc
v_add_f32_dpp v32, v32, v32 row_half_mirror row_mask:0xf bank_mask:0x5
v_add_f32_dpp v32, v36, v36 row_half_mirror row_mask:0xf bank_mask:0xa
v_add_f32_dpp v33, v33, v33 row_half_mirror row_mask:0xf bank_mask:0x5
v_add_f32_dpp v33, v37, v37 row_half_mirror row_mask:0xf bank_mask:0xa
v_add_f32_dpp v34, v34, v34 row_half_mirror row_mask:0xf bank_mask:0x5
v_add_f32_dpp v34, v38, v38 row_half_mirror row_mask:0xf bank_mask:0xa
v_add_f32_dpp v35, v35, v35 row_half_mirror row_mask:0xf bank_mask:0x5
v_add_f32_dpp v35, v39, v39 row_half_mirror row_mask:0xf bank_mask:0xa
v_cndmask_b32 v28, v33, v32, s[36:37]
v_cndmask_b32 v29, v32, v33, s[36:37]
v_cndmask_b32 v30, v35, v34, s[36:37]
v_cndmask_b32 v31, v34, v35, s[36:37]
v_add_f32_dpp v29, v28, v29 quad_perm:[1,0,3,2] row_mask:0xf bank_mask:0xf
v_add_f32_dpp v31, v30, v31 quad_perm:[1,0,3,2] row_mask:0xf bank_mask:0xf
v_cndmask_b32 v28, v31, v29, s[38:39]
v_cndmask_b32 v30, v29, v31, s[38:39]
s_nop 0
v_add_f32_dpp v30, v28, v30 quad_perm:[2,3,0,1] row_mask:0xf bank_mask:0xf
v_cvt_pk_bf16_f32 v30, v30, v30
v_lshlrev_b32 v30, 16, v30
v_mul_f32 v30, 0x3db504f3, v30
v_cvt_pk_bf16_f32 v30, v30, v30
v_lshlrev_b32 v30, 16, v30
v_max_f32 v24, v30, v24
ds_write_b32 v58, v30 offset:25792
v_add_u32 v58, 256, v58
s_add_u32 s65, s65, 1
v_mov_b32 v26, s65
ds_max_u32 v27, v26
L_k:
s_add_u32 s52, s52, s53
s_cmp_lg_u32 s65, 10
s_cbranch_scc1 L_k2
s_mov_b32 s72, s55
s_atomic_add s72, s[74:75], 0 glc
L_k2:
s_waitcnt vmcnt(15)
v_dot2_f32_bf16 v32, v128, v4, 0
v_dot2_f32_bf16 v32, v129, v5, v32
v_dot2_f32_bf16 v32, v130, v6, v32
v_dot2_f32_bf16 v32, v131, v7, v32
s_add_u32 s22, s52, 0
buffer_load_dwordx4 v[128:131], v1, s[4:7], s22 offen offset:0 nt
s_waitcnt vmcnt(15)
v_dot2_f32_bf16 v33, v132, v4, 0
v_dot2_f32_bf16 v33, v133, v5, v33
v_dot2_f32_bf16 v33, v134, v6, v33
v_dot2_f32_bf16 v33, v135, v7, v33
buffer_load_dwordx4 v[132:135], v1, s[4:7], s22 offen offset:1024 nt
s_waitcnt vmcnt(15)
v_dot2_f32_bf16 v34, v136, v4, 0
v_dot2_f32_bf16 v34, v137, v5, v34
v_dot2_f32_bf16 v34, v138, v6, v34
v_dot2_f32_bf16 v34, v139, v7, v34
buffer_load_dwordx4 v[136:139], v1, s[4:7], s22 offen offset:2048 nt
s_waitcnt vmcnt(15)
v_dot2_f32_bf16 v35, v140, v4, 0
v_dot2_f32_bf16 v35, v141, v5, v35
v_dot2_f32_bf16 v35, v142, v6, v35
v_dot2_f32_bf16 v35, v143, v7, v35
buffer_load_dwordx4 v[140:143], v1, s[4:7], s22 offen offset:3072 nt
s_waitcnt vmcnt(15)
v_dot2_f32_bf16 v36, v144, v4, 0
v_dot2_f32_bf16 v36, v145, v5, v36
v_dot2_f32_bf16 v36, v146, v6, v36
v_dot2_f32_bf16 v36, v147, v7, v36
s_add_u32 s22, s52, 16384
buffer_load_dwordx4 v[144:147], v1, s[4:7], s22 offen offset:0 nt
s_waitcnt vmcnt(15)
v_dot2_f32_bf16 v37, v148, v4, 0
v_dot2_f32_bf16 v37, v149, v5, v37
v_dot2_f32_bf16 v37, v150, v6, v37
v_dot2_f32_bf16 v37, v151, v7, v37
buffer_load_dwordx4 v[148:151], v1, s[4:7], s22 offen offset:1024 nt
s_waitcnt vmcnt(15)
v_dot2_f32_bf16 v38, v152, v4, 0
v_dot2_f32_bf16 v38, v153, v5, v38
v_dot2_f32_bf16 v38, v154, v6, v38
v_dot2_f32_bf16 v38, v155, v7, v38
buffer_load_dwordx4 v[152:155], v1, s[4:7], s22 offen offset:2048 nt
s_waitcnt vmcnt(15)
v_dot2_f32_bf16 v39, v156, v4, 0
v_dot2_f32_bf16 v39, v157, v5, v39
v_dot2_f32_bf16 v39, v158, v6, v39
v_dot2_f32_bf16 v39, v159, v7, v39
buffer_load_dwordx4 v[156:159], v1, s[4:7], s22 offen offset:3072 nt
s_waitcnt vmcnt(15)
v_dot2_f32_bf16 v40, v160, v4, 0
v_dot2_f32_bf16 v40, v161, v5, v40
v_dot2_f32_bf16 v40, v162, v6, v40
v_dot2_f32_bf16 v40, v163, v7, v40
s_add_u32 s22, s52, 32768
buffer_load_dwordx4 v[160:163], v1, s[4:7], s22 offen offset:0 nt
s_waitcnt vmcnt(15)
v_dot2_f32_bf16 v41, v164, v4, 0
v_dot2_f32_bf16 v41, v165, v5, v41
v_dot2_f32_bf16 v41, v166, v6, v41
v_dot2_f32_bf16 v41, v167, v7, v41
buffer_load_dwordx4 v[164:167], v1, s[4:7], s22 offen offset:1024 nt
s_waitcnt vmcnt(15)
v_dot2_f32_bf16 v42, v168, v4, 0
v_dot2_f32_bf16 v42, v169, v5, v42
v_dot2_f32_bf16 v42, v170, v6, v42
v_dot2_f32_bf16 v42, v171, v7, v42
buffer_load_dwordx4 v[168:171], v1, s[4:7], s22 offen offset:2048 nt
s_waitcnt vmcnt(15)
v_dot2_f32_bf16 v43, v172, v4, 0
v_dot2_f32_bf16 v43, v173, v5, v43
v_dot2_f32_bf16 v43, v174, v6, v43
v_dot2_f32_bf16 v43, v175, v7, v43
buffer_load_dwordx4 v[172:175], v1, s[4:7], s22 offen offset:3072 nt
s_waitcnt vmcnt(15)
v_dot2_f32_bf16 v44, v176, v4, 0
v_dot2_f32_bf16 v44, v177, v5, v44
v_dot2_f32_bf16 v44, v178, v6, v44
v_dot2_f32_bf16 v44, v179, v7, v44
s_add_u32 s22, s52, 49152
buffer_load_dwordx4 v[176:179], v1, s[4:7], s22 offen offset:0 nt
s_waitcnt vmcnt(15)
v_dot2_f32_bf16 v45, v180, v4, 0
v_dot2_f32_bf16 v45, v181, v5, v45
v_dot2_f32_bf16 v45, v182, v6, v45
v_dot2_f32_bf16 v45, v183, v7, v45
buffer_load_dwordx4 v[180:183], v1, s[4:7], s22 offen offset:1024 nt
s_waitcnt vmcnt(15)
v_dot2_f32_bf16 v46, v184, v4, 0
v_dot2_f32_bf16 v46, v185, v5, v46
v_dot2_f32_bf16 v46, v186, v6, v46
v_dot2_f32_bf16 v46, v187, v7, v46
buffer_load_dwordx4 v[184:187], v1, s[4:7], s22 offen offset:2048 nt
s_waitcnt vmcnt(15)
v_dot2_f32_bf16 v47, v188, v4, 0
v_dot2_f32_bf16 v47, v189, v5, v47
v_dot2_f32_bf16 v47, v190, v6, v47
v_dot2_f32_bf16 v47, v191, v7, v47
buffer_load_dwordx4 v[188:191], v1, s[4:7], s22 offen offset:3072 nt
v_add_f32_dpp v32, v32, v32 row_ror:8 row_mask:0xf bank_mask:0x3
v_add_f32_dpp v32, v40, v40 row_ror:8 row_mask:0xf bank_mask:0xc
v_add_f32_dpp v33, v33, v33 row_ror:8 row_mask:0xf bank_mask:0x3
v_add_f32_dpp v33, v41, v41 row_ror:8 row_mask:0xf bank_mask:0xc
v_add_f32_dpp v34, v34, v34 row_ror:8 row_mask:0xf bank_mask:0x3
v_add_f32_dpp v34, v42, v42 row_ror:8 row_mask:0xf bank_mask:0xc
v_add_f32_dpp v35, v35, v35 row_ror:8 row_mask:0xf bank_mask:0x3
v_add_f32_dpp v35, v43, v43 row_ror:8 row_mask:0xf bank_mask:0xc
v_add_f32_dpp v36, v36, v36 row_ror:8 row_mask:0xf bank_mask:0x3
v_add_f32_dpp v36, v44, v44 row_ror:8 row_mask:0xf bank_mask:0xc
v_add_f32_dpp v37, v37, v37 row_ror:8 row_mask:0xf bank_mask:0x3
v_add_f32_dpp v37, v45, v45 row_ror:8 row_mask:0xf bank_mask:0xc
v_add_f32_dpp v38, v38, v38 row_ror:8 row_mask:0xf bank_mask:0x3
v_add_f32_dpp v38, v46, v46 row_ror:8 row_mask:0xf bank_mask:0xc
v_add_f32_dpp v39, v39, v39 row_ror:8 row_mask:0xf bank_mask:0x3
v_add_f32_dpp v39, v47, v47 row_ror:8 row_mask:0xf bank_mask:0xc
v_add_f32_dpp v32, v32, v32 row_half_mirror row_mask:0xf bank_mask:0x5
v_add_f32_dpp v32, v36, v36 row_half_mirror row_mask:0xf bank_mask:0xa
v_add_f32_dpp v33, v33, v33 row_half_mirror row_mask:0xf bank_mask:0x5
v_add_f32_dpp v33, v37, v37 row_half_mirror row_mask:0xf bank_mask:0xa
v_add_f32_dpp v34, v34, v34 row_half_mirror row_mask:0xf bank_mask:0x5
v_add_f32_dpp v34, v38, v38 row_half_mirror row_mask:0xf bank_mask:0xa
v_add_f32_dpp v35, v35, v35 row_half_mirror row_mask:0xf bank_mask:0x5
v_add_f32_dpp v35, v39, v39 row_half_mirror row_mask:0xf bank_mask:0xa
v_cndmask_b32 v28, v33, v32, s[36:37]
v_cndmask_b32 v29, v32, v33, s[36:37]
v_cndmask_b32 v30, v35, v34, s[36:37]
v_cndmask_b32 v31, v34, v35, s[36:37]
v_add_f32_dpp v29, v28, v29 quad_perm:[1,0,3,2] row_mask:0xf bank_mask:0xf
v_add_f32_dpp v31, v30, v31 quad_perm:[1,0,3,2] row_mask:0xf bank_mask:0xf
v_cndmask_b32 v28, v31, v29, s[38:39]
v_cndmask_b32 v30, v29, v31, s[38:39]
s_nop 0
v_add_f32_dpp v30, v28, v30 quad_perm:[2,3,0,1] row_mask:0xf bank_mask:0xf
v_cvt_pk_bf16_f32 v30, v30, v30
v_lshlrev_b32 v30, 16, v30
v_mul_f32 v30, 0x3db504f3, v30
v_cvt_pk_bf16_f32 v30, v30, v30
v_lshlrev_b32 v30, 16, v30
v_max_f32 v24, v30, v24
ds_write_b32 v58, v30 offset:25792
v_add_u32 v58, 256, v58
s_add_u32 s65, s65, 1
v_mov_b32 v26, s65
ds_max_u32 v27, v26
s_cmp_lt_u32 s65, 11
s_cbranch_scc1 L_k
s_mov_b32 s86, 0
s_waitcnt lgkmcnt(0)
s_sub_u32 s72, s72, s71
s_and_b32 s42, s72, 0xffff
s_lshr_b32 s43, s72, 16
s_add_u32 s42, s42, s43
s_cmp_ge_u32 s42, 32
s_cbranch_scc1 L_kl0
s_lshr_b32 s72, s72, s56
s_and_b32 s72, s72, 0xffff
s_add_u32 s72, s72, 48
s_sub_u32 s40, 127, s72
s_cmp_eq_u32 s48, 0
s_cselect_b32 s40, s72, s40
s_lshr_b32 s41, s40, 2
s_lshl_b32 s41, s41, 16
s_and_b32 s42, s40, 3
s_lshl_b32 s42, s42, 12
s_add_u32 s52, s54, s41
s_add_u32 s52, s52, s42
s_lshl_b32 s59, s40, 8
s_add_u32 s59, s59, s73
s_mov_b32 s72, s55
s_atomic_add s72, s[74:75], 0 glc
s_mov_b32 s86, 1
s_branch L_kl1
L_kl0:
s_mov_b32 s52, s57
s_mov_b32 s4, s8
s_mov_b32 s5, s9
L_kl1:
s_waitcnt vmcnt(15)
v_dot2_f32_bf16 v32, v128, v4, 0
v_dot2_f32_bf16 v32, v129, v5, v32
v_dot2_f32_bf16 v32, v130, v6, v32
v_dot2_f32_bf16 v32, v131, v7, v32
s_add_u32 s22, s52, 0
buffer_load_dwordx4 v[128:131], v1, s[4:7], s22 offen offset:0 nt
s_waitcnt vmcnt(15)
v_dot2_f32_bf16 v33, v132, v4, 0
v_dot2_f32_bf16 v33, v133, v5, v33
v_dot2_f32_bf16 v33, v134, v6, v33
v_dot2_f32_bf16 v33, v135, v7, v33
buffer_load_dwordx4 v[132:135], v1, s[4:7], s22 offen offset:1024 nt
s_waitcnt vmcnt(15)
v_dot2_f32_bf16 v34, v136, v4, 0
v_dot2_f32_bf16 v34, v137, v5, v34
v_dot2_f32_bf16 v34, v138, v6, v34
v_dot2_f32_bf16 v34, v139, v7, v34
buffer_load_dwordx4 v[136:139], v1, s[4:7], s22 offen offset:2048 nt
s_waitcnt vmcnt(15)
v_dot2_f32_bf16 v35, v140, v4, 0
v_dot2_f32_bf16 v35, v141, v5, v35
v_dot2_f32_bf16 v35, v142, v6, v35
v_dot2_f32_bf16 v35, v143, v7, v35
buffer_load_dwordx4 v[140:143], v1, s[4:7], s22 offen offset:3072 nt
s_waitcnt vmcnt(15)
v_dot2_f32_bf16 v36, v144, v4, 0
v_dot2_f32_bf16 v36, v145, v5, v36
v_dot2_f32_bf16 v36, v146, v6, v36
v_dot2_f32_bf16 v36, v147, v7, v36
s_add_u32 s22, s52, 16384
buffer_load_dwordx4 v[144:147], v1, s[4:7], s22 offen offset:0 nt
s_waitcnt vmcnt(15)
v_dot2_f32_bf16 v37, v148, v4, 0
v_dot2_f32_bf16 v37, v149, v5, v37
v_dot2_f32_bf16 v37, v150, v6, v37
v_dot2_f32_bf16 v37, v151, v7, v37
buffer_load_dwordx4 v[148:151], v1, s[4:7], s22 offen offset:1024 nt
s_waitcnt vmcnt(15)
v_dot2_f32_bf16 v38, v152, v4, 0
v_dot2_f32_bf16 v38, v153, v5, v38
v_dot2_f32_bf16 v38, v154, v6, v38
v_dot2_f32_bf16 v38, v155, v7, v38
buffer_load_dwordx4 v[152:155], v1, s[4:7], s22 offen offset:2048 nt
s_waitcnt vmcnt(15)
v_dot2_f32_bf16 v39, v156, v4, 0
v_dot2_f32_bf16 v39, v157, v5, v39
v_dot2_f32_bf16 v39, v158, v6, v39
v_dot2_f32_bf16 v39, v159, v7, v39
buffer_load_dwordx4 v[156:159], v1, s[4:7], s22 offen offset:3072 nt
s_waitcnt vmcnt(15)
v_dot2_f32_bf16 v40, v160, v4, 0
v_dot2_f32_bf16 v40, v161, v5, v40
v_dot2_f32_bf16 v40, v162, v6, v40
v_dot2_f32_bf16 v40, v163, v7, v40
s_add_u32 s22, s52, 32768
buffer_load_dwordx4 v[160:163], v1, s[4:7], s22 offen offset:0 nt
s_waitcnt vmcnt(15)
v_dot2_f32_bf16 v41, v164, v4, 0
v_dot2_f32_bf16 v41, v165, v5, v41
v_dot2_f32_bf16 v41, v166, v6, v41
v_dot2_f32_bf16 v41, v167, v7, v41
buffer_load_dwordx4 v[164:167], v1, s[4:7], s22 offen offset:1024 nt
s_waitcnt vmcnt(15)
v_dot2_f32_bf16 v42, v168, v4, 0
v_dot2_f32_bf16 v42, v169, v5, v42
v_dot2_f32_bf16 v42, v170, v6, v42
v_dot2_f32_bf16 v42, v171, v7, v42
buffer_load_dwordx4 v[168:171], v1, s[4:7], s22 offen offset:2048 nt
s_waitcnt vmcnt(15)
v_dot2_f32_bf16 v43, v172, v4, 0
v_dot2_f32_bf16 v43, v173, v5, v43
v_dot2_f32_bf16 v43, v174, v6, v43
v_dot2_f32_bf16 v43, v175, v7, v43
buffer_load_dwordx4 v[172:175], v1, s[4:7], s22 offen offset:3072 nt
s_waitcnt vmcnt(15)
v_dot2_f32_bf16 v44, v176, v4, 0
v_dot2_f32_bf16 v44, v177, v5, v44
v_dot2_f32_bf16 v44, v178, v6, v44
v_dot2_f32_bf16 v44, v179, v7, v44
s_add_u32 s22, s52, 49152
buffer_load_dwordx4 v[176:179], v1, s[4:7], s22 offen offset:0 nt
s_waitcnt vmcnt(15)
v_dot2_f32_bf16 v45, v180, v4, 0
v_dot2_f32_bf16 v45, v181, v5, v45
v_dot2_f32_bf16 v45, v182, v6, v45
v_dot2_f32_bf16 v45, v183, v7, v45
buffer_load_dwordx4 v[180:183], v1, s[4:7], s22 offen offset:1024 nt
s_waitcnt vmcnt(15)
v_dot2_f32_bf16 v46, v184, v4, 0
v_dot2_f32_bf16 v46, v185, v5, v46
v_dot2_f32_bf16 v46, v186, v6, v46
v_dot2_f32_bf16 v46, v187, v7, v46
buffer_load_dwordx4 v[184:187], v1, s[4:7], s22 offen offset:2048 nt
s_waitcnt vmcnt(15)
v_dot2_f32_bf16 v47, v188, v4, 0
v_dot2_f32_bf16 v47, v189, v5, v47
v_dot2_f32_bf16 v47, v190, v6, v47
v_dot2_f32_bf16 v47, v191, v7, v47
buffer_load_dwordx4 v[188:191], v1, s[4:7], s22 offen offset:3072 nt
v_add_f32_dpp v32, v32, v32 row_ror:8 row_mask:0xf bank_mask:0x3
v_add_f32_dpp v32, v40, v40 row_ror:8 row_mask:0xf bank_mask:0xc
v_add_f32_dpp v33, v33, v33 row_ror:8 row_mask:0xf bank_mask:0x3
v_add_f32_dpp v33, v41, v41 row_ror:8 row_mask:0xf bank_mask:0xc
v_add_f32_dpp v34, v34, v34 row_ror:8 row_mask:0xf bank_mask:0x3
v_add_f32_dpp v34, v42, v42 row_ror:8 row_mask:0xf bank_mask:0xc
v_add_f32_dpp v35, v35, v35 row_ror:8 row_mask:0xf bank_mask:0x3
v_add_f32_dpp v35, v43, v43 row_ror:8 row_mask:0xf bank_mask:0xc
v_add_f32_dpp v36, v36, v36 row_ror:8 row_mask:0xf bank_mask:0x3
v_add_f32_dpp v36, v44, v44 row_ror:8 row_mask:0xf bank_mask:0xc
v_add_f32_dpp v37, v37, v37 row_ror:8 row_mask:0xf bank_mask:0x3
v_add_f32_dpp v37, v45, v45 row_ror:8 row_mask:0xf bank_mask:0xc
v_add_f32_dpp v38, v38, v38 row_ror:8 row_mask:0xf bank_mask:0x3
v_add_f32_dpp v38, v46, v46 row_ror:8 row_mask:0xf bank_mask:0xc
v_add_f32_dpp v39, v39, v39 row_ror:8 row_mask:0xf bank_mask:0x3
v_add_f32_dpp v39, v47, v47 row_ror:8 row_mask:0xf bank_mask:0xc
v_add_f32_dpp v32, v32, v32 row_half_mirror row_mask:0xf bank_mask:0x5
v_add_f32_dpp v32, v36, v36 row_half_mirror row_mask:0xf bank_mask:0xa
v_add_f32_dpp v33, v33, v33 row_half_mirror row_mask:0xf bank_mask:0x5
v_add_f32_dpp v33, v37, v37 row_half_mirror row_mask:0xf bank_mask:0xa
v_add_f32_dpp v34, v34, v34 row_half_mirror row_mask:0xf bank_mask:0x5
v_add_f32_dpp v34, v38, v38 row_half_mirror row_mask:0xf bank_mask:0xa
v_add_f32_dpp v35, v35, v35 row_half_mirror row_mask:0xf bank_mask:0x5
v_add_f32_dpp v35, v39, v39 row_half_mirror row_mask:0xf bank_mask:0xa
v_cndmask_b32 v28, v33, v32, s[36:37]
v_cndmask_b32 v29, v32, v33, s[36:37]
v_cndmask_b32 v30, v35, v34, s[36:37]
v_cndmask_b32 v31, v34, v35, s[36:37]
v_add_f32_dpp v29, v28, v29 quad_perm:[1,0,3,2] row_mask:0xf bank_mask:0xf
v_add_f32_dpp v31, v30, v31 quad_perm:[1,0,3,2] row_mask:0xf bank_mask:0xf
v_cndmask_b32 v28, v31, v29, s[38:39]
v_cndmask_b32 v30, v29, v31, s[38:39]
s_nop 0
v_add_f32_dpp v30, v28, v30 quad_perm:[2,3,0,1] row_mask:0xf bank_mask:0xf
v_cvt_pk_bf16_f32 v30, v30, v30
v_lshlrev_b32 v30, 16, v30
v_mul_f32 v30, 0x3db504f3, v30
v_cvt_pk_bf16_f32 v30, v30, v30
v_lshlrev_b32 v30, 16, v30
v_max_f32 v24, v30, v24
ds_write_b32 v58, v30 offset:25792
v_add_u32 v58, 256, v58
s_add_u32 s65, s65, 1
v_mov_b32 v26, s65
ds_max_u32 v27, v26
s_cmp_eq_u32 s86, 0
s_cbranch_scc1 L_kdone
L_kd:
s_mov_b32 s58, s59
s_mov_b32 s86, 0
s_waitcnt lgkmcnt(0)
s_sub_u32 s72, s72, s71
s_and_b32 s42, s72, 0xffff
s_lshr_b32 s43, s72, 16
s_add_u32 s42, s42, s43
s_cmp_ge_u32 s42, 32
s_cbranch_scc1 L_kd0
s_lshr_b32 s72, s72, s56
s_and_b32 s72, s72, 0xffff
s_add_u32 s72, s72, 48
s_sub_u32 s40, 127, s72
s_cmp_eq_u32 s48, 0
s_cselect_b32 s40, s72, s40
s_lshr_b32 s41, s40, 2
s_lshl_b32 s41, s41, 16
s_and_b32 s42, s40, 3
s_lshl_b32 s42, s42, 12
s_add_u32 s52, s54, s41
s_add_u32 s52, s52, s42
s_lshl_b32 s59, s40, 8
s_add_u32 s59, s59, s73
s_mov_b32 s72, s55
s_atomic_add s72, s[74:75], 0 glc
s_mov_b32 s86, 1
s_branch L_kd1
L_kd0:
s_mov_b32 s52, s57
s_mov_b32 s4, s8
s_mov_b32 s5, s9
L_kd1:
s_waitcnt vmcnt(15)
v_dot2_f32_bf16 v32, v128, v4, 0
v_dot2_f32_bf16 v32, v129, v5, v32
v_dot2_f32_bf16 v32, v130, v6, v32
v_dot2_f32_bf16 v32, v131, v7, v32
s_add_u32 s22, s52, 0
buffer_load_dwordx4 v[128:131], v1, s[4:7], s22 offen offset:0 nt
s_waitcnt vmcnt(15)
v_dot2_f32_bf16 v33, v132, v4, 0
v_dot2_f32_bf16 v33, v133, v5, v33
v_dot2_f32_bf16 v33, v134, v6, v33
v_dot2_f32_bf16 v33, v135, v7, v33
buffer_load_dwordx4 v[132:135], v1, s[4:7], s22 offen offset:1024 nt
s_waitcnt vmcnt(15)
v_dot2_f32_bf16 v34, v136, v4, 0
v_dot2_f32_bf16 v34, v137, v5, v34
v_dot2_f32_bf16 v34, v138, v6, v34
v_dot2_f32_bf16 v34, v139, v7, v34
buffer_load_dwordx4 v[136:139], v1, s[4:7], s22 offen offset:2048 nt
s_waitcnt vmcnt(15)
v_dot2_f32_bf16 v35, v140, v4, 0
v_dot2_f32_bf16 v35, v141, v5, v35
v_dot2_f32_bf16 v35, v142, v6, v35
v_dot2_f32_bf16 v35, v143, v7, v35
buffer_load_dwordx4 v[140:143], v1, s[4:7], s22 offen offset:3072 nt
s_waitcnt vmcnt(15)
v_dot2_f32_bf16 v36, v144, v4, 0
v_dot2_f32_bf16 v36, v145, v5, v36
v_dot2_f32_bf16 v36, v146, v6, v36
v_dot2_f32_bf16 v36, v147, v7, v36
s_add_u32 s22, s52, 16384
buffer_load_dwordx4 v[144:147], v1, s[4:7], s22 offen offset:0 nt
s_waitcnt vmcnt(15)
v_dot2_f32_bf16 v37, v148, v4, 0
v_dot2_f32_bf16 v37, v149, v5, v37
v_dot2_f32_bf16 v37, v150, v6, v37
v_dot2_f32_bf16 v37, v151, v7, v37
buffer_load_dwordx4 v[148:151], v1, s[4:7], s22 offen offset:1024 nt
s_waitcnt vmcnt(15)
v_dot2_f32_bf16 v38, v152, v4, 0
v_dot2_f32_bf16 v38, v153, v5, v38
v_dot2_f32_bf16 v38, v154, v6, v38
v_dot2_f32_bf16 v38, v155, v7, v38
buffer_load_dwordx4 v[152:155], v1, s[4:7], s22 offen offset:2048 nt
s_waitcnt vmcnt(15)
v_dot2_f32_bf16 v39, v156, v4, 0
v_dot2_f32_bf16 v39, v157, v5, v39
v_dot2_f32_bf16 v39, v158, v6, v39
v_dot2_f32_bf16 v39, v159, v7, v39
buffer_load_dwordx4 v[156:159], v1, s[4:7], s22 offen offset:3072 nt
s_waitcnt vmcnt(15)
v_dot2_f32_bf16 v40, v160, v4, 0
v_dot2_f32_bf16 v40, v161, v5, v40
v_dot2_f32_bf16 v40, v162, v6, v40
v_dot2_f32_bf16 v40, v163, v7, v40
s_add_u32 s22, s52, 32768
buffer_load_dwordx4 v[160:163], v1, s[4:7], s22 offen offset:0 nt
s_waitcnt vmcnt(15)
v_dot2_f32_bf16 v41, v164, v4, 0
v_dot2_f32_bf16 v41, v165, v5, v41
v_dot2_f32_bf16 v41, v166, v6, v41
v_dot2_f32_bf16 v41, v167, v7, v41
buffer_load_dwordx4 v[164:167], v1, s[4:7], s22 offen offset:1024 nt
s_waitcnt vmcnt(15)
v_dot2_f32_bf16 v42, v168, v4, 0
v_dot2_f32_bf16 v42, v169, v5, v42
v_dot2_f32_bf16 v42, v170, v6, v42
v_dot2_f32_bf16 v42, v171, v7, v42
buffer_load_dwordx4 v[168:171], v1, s[4:7], s22 offen offset:2048 nt
s_waitcnt vmcnt(15)
v_dot2_f32_bf16 v43, v172, v4, 0
v_dot2_f32_bf16 v43, v173, v5, v43
v_dot2_f32_bf16 v43, v174, v6, v43
v_dot2_f32_bf16 v43, v175, v7, v43
buffer_load_dwordx4 v[172:175], v1, s[4:7], s22 offen offset:3072 nt
s_waitcnt vmcnt(15)
v_dot2_f32_bf16 v44, v176, v4, 0
v_dot2_f32_bf16 v44, v177, v5, v44
v_dot2_f32_bf16 v44, v178, v6, v44
v_dot2_f32_bf16 v44, v179, v7, v44
s_add_u32 s22, s52, 49152
buffer_load_dwordx4 v[176:179], v1, s[4:7], s22 offen offset:0 nt
s_waitcnt vmcnt(15)
v_dot2_f32_bf16 v45, v180, v4, 0
v_dot2_f32_bf16 v45, v181, v5, v45
v_dot2_f32_bf16 v45, v182, v6, v45
v_dot2_f32_bf16 v45, v183, v7, v45
buffer_load_dwordx4 v[180:183], v1, s[4:7], s22 offen offset:1024 nt
s_waitcnt vmcnt(15)
v_dot2_f32_bf16 v46, v184, v4, 0
v_dot2_f32_bf16 v46, v185, v5, v46
v_dot2_f32_bf16 v46, v186, v6, v46
v_dot2_f32_bf16 v46, v187, v7, v46
buffer_load_dwordx4 v[184:187], v1, s[4:7], s22 offen offset:2048 nt
s_waitcnt vmcnt(15)
v_dot2_f32_bf16 v47, v188, v4, 0
v_dot2_f32_bf16 v47, v189, v5, v47
v_dot2_f32_bf16 v47, v190, v6, v47
v_dot2_f32_bf16 v47, v191, v7, v47
buffer_load_dwordx4 v[188:191], v1, s[4:7], s22 offen offset:3072 nt
v_add_f32_dpp v32, v32, v32 row_ror:8 row_mask:0xf bank_mask:0x3
v_add_f32_dpp v32, v40, v40 row_ror:8 row_mask:0xf bank_mask:0xc
v_add_f32_dpp v33, v33, v33 row_ror:8 row_mask:0xf bank_mask:0x3
v_add_f32_dpp v33, v41, v41 row_ror:8 row_mask:0xf bank_mask:0xc
v_add_f32_dpp v34, v34, v34 row_ror:8 row_mask:0xf bank_mask:0x3
v_add_f32_dpp v34, v42, v42 row_ror:8 row_mask:0xf bank_mask:0xc
v_add_f32_dpp v35, v35, v35 row_ror:8 row_mask:0xf bank_mask:0x3
v_add_f32_dpp v35, v43, v43 row_ror:8 row_mask:0xf bank_mask:0xc
v_add_f32_dpp v36, v36, v36 row_ror:8 row_mask:0xf bank_mask:0x3
v_add_f32_dpp v36, v44, v44 row_ror:8 row_mask:0xf bank_mask:0xc
v_add_f32_dpp v37, v37, v37 row_ror:8 row_mask:0xf bank_mask:0x3
v_add_f32_dpp v37, v45, v45 row_ror:8 row_mask:0xf bank_mask:0xc
v_add_f32_dpp v38, v38, v38 row_ror:8 row_mask:0xf bank_mask:0x3
v_add_f32_dpp v38, v46, v46 row_ror:8 row_mask:0xf bank_mask:0xc
v_add_f32_dpp v39, v39, v39 row_ror:8 row_mask:0xf bank_mask:0x3
v_add_f32_dpp v39, v47, v47 row_ror:8 row_mask:0xf bank_mask:0xc
v_add_f32_dpp v32, v32, v32 row_half_mirror row_mask:0xf bank_mask:0x5
v_add_f32_dpp v32, v36, v36 row_half_mirror row_mask:0xf bank_mask:0xa
v_add_f32_dpp v33, v33, v33 row_half_mirror row_mask:0xf bank_mask:0x5
v_add_f32_dpp v33, v37, v37 row_half_mirror row_mask:0xf bank_mask:0xa
v_add_f32_dpp v34, v34, v34 row_half_mirror row_mask:0xf bank_mask:0x5
v_add_f32_dpp v34, v38, v38 row_half_mirror row_mask:0xf bank_mask:0xa
v_add_f32_dpp v35, v35, v35 row_half_mirror row_mask:0xf bank_mask:0x5
v_add_f32_dpp v35, v39, v39 row_half_mirror row_mask:0xf bank_mask:0xa
v_cndmask_b32 v28, v33, v32, s[36:37]
v_cndmask_b32 v29, v32, v33, s[36:37]
v_cndmask_b32 v30, v35, v34, s[36:37]
v_cndmask_b32 v31, v34, v35, s[36:37]
v_add_f32_dpp v29, v28, v29 quad_perm:[1,0,3,2] row_mask:0xf bank_mask:0xf
v_add_f32_dpp v31, v30, v31 quad_perm:[1,0,3,2] row_mask:0xf bank_mask:0xf
v_cndmask_b32 v28, v31, v29, s[38:39]
v_cndmask_b32 v30, v29, v31, s[38:39]
s_nop 0
v_add_f32_dpp v30, v28, v30 quad_perm:[2,3,0,1] row_mask:0xf bank_mask:0xf
v_cvt_pk_bf16_f32 v30, v30, v30
v_lshlrev_b32 v30, 16, v30
v_mul_f32 v30, 0x3db504f3, v30
v_cvt_pk_bf16_f32 v30, v30, v30
v_lshlrev_b32 v30, 16, v30
v_max_f32 v24, v30, v24
buffer_store_dword v30, v60, s[12:15], s58 offen sc1
s_cmp_lg_u32 s86, 0
s_cbranch_scc1 L_kd
L_kdone:
s_nop 1
v_max_f32_dpp v24, v24, v24 quad_perm:[1,0,3,2] row_mask:0xf bank_mask:0xf
s_nop 1
v_max_f32_dpp v24, v24, v24 quad_perm:[2,3,0,1] row_mask:0xf bank_mask:0xf
s_nop 1
v_max_f32_dpp v24, v24, v24 row_half_mirror row_mask:0xf bank_mask:0xf
s_nop 1
v_max_f32_dpp v24, v24, v24 row_mirror row_mask:0xf bank_mask:0xf
s_nop 1
v_mov_b32 v29, v24
s_nop 1
v_permlane16_swap_b32 v24, v29
s_nop 1
v_max_f32 v24, v24, v29
v_mov_b32 v29, v24
s_nop 1
v_permlane32_swap_b32 v24, v29
s_nop 1
v_max_f32 v24, v24, v29
s_lshl_b32 s40, s3, 2
v_add_u32 v28, s40, v61
ds_write_b32 v28, v24 offset:16
s_waitcnt lgkmcnt(0)
ds_read_b32 v31, v59 offset:25792
v_add_u32 v59, 256, v59
s_mov_b32 s64, 0
L_v:
s_add_u32 s52, s52, s53
s_waitcnt lgkmcnt(0)
s_cmp_lg_u32 s64, 10
s_cbranch_scc1 L_v2
L_vw:
ds_read_b128 v[32:35], v61
ds_read_b128 v[36:39], v61 offset:16
s_waitcnt lgkmcnt(0)
v_readfirstlane_b32 s40, v34
s_cmp_lg_u32 s40, 0
s_cbranch_scc1 L_vw1
s_sleep 8
s_branch L_vw
L_vw1:
v_max3_f32 v35, v35, v36, v37
v_max3_f32 v35, v35, v38, v39
v_sub_f32 v29, v24, v35
v_mul_f32 v29, 0x3fb8aa3b, v29
v_exp_f32 v29, v29
v_mov_b32 v24, v35
v_mul_f32 v25, v25, v29
v_mul_f32 v20, v20, v29
v_mul_f32 v21, v21, v29
v_mul_f32 v22, v22, v29
v_mul_f32 v23, v23, v29
s_mov_b32 s72, s55
s_atomic_add s72, s[74:75], 4 glc
L_v2:
v_sub_f32 v30, v31, v24
v_mul_f32 v30, 0x3fb8aa3b, v30
v_exp_f32 v30, v30
ds_read_b32 v31, v59 offset:25792
v_add_u32 v59, 256, v59
s_nop 0
v_add_f32 v25, v25, v30
v_cvt_pk_bf16_f32 v30, v30, v30
s_nop 1
v_and_b32_dpp v12, v30, v8 row_newbcast:0 row_mask:0xf bank_mask:0xf
v_and_b32_dpp v13, v30, v9 row_newbcast:0 row_mask:0xf bank_mask:0xf
v_and_b32_dpp v14, v30, v10 row_newbcast:0 row_mask:0xf bank_mask:0xf
v_and_b32_dpp v15, v30, v11 row_newbcast:0 row_mask:0xf bank_mask:0xf
s_waitcnt vmcnt(15)
s_nop 0
v_mfma_f32_16x16x32_bf16 v[20:23], v[128:131], v[12:15], v[20:23]
s_add_u32 s22, s52, 0
buffer_load_dwordx4 v[128:131], v1, s[4:7], s22 offen offset:0 nt
v_and_b32_dpp v16, v30, v8 row_newbcast:1 row_mask:0xf bank_mask:0xf
v_and_b32_dpp v17, v30, v9 row_newbcast:1 row_mask:0xf bank_mask:0xf
v_and_b32_dpp v18, v30, v10 row_newbcast:1 row_mask:0xf bank_mask:0xf
v_and_b32_dpp v19, v30, v11 row_newbcast:1 row_mask:0xf bank_mask:0xf
s_waitcnt vmcnt(15)
s_nop 0
v_mfma_f32_16x16x32_bf16 v[20:23], v[132:135], v[16:19], v[20:23]
buffer_load_dwordx4 v[132:135], v1, s[4:7], s22 offen offset:1024 nt
v_and_b32_dpp v12, v30, v8 row_newbcast:2 row_mask:0xf bank_mask:0xf
v_and_b32_dpp v13, v30, v9 row_newbcast:2 row_mask:0xf bank_mask:0xf
v_and_b32_dpp v14, v30, v10 row_newbcast:2 row_mask:0xf bank_mask:0xf
v_and_b32_dpp v15, v30, v11 row_newbcast:2 row_mask:0xf bank_mask:0xf
s_waitcnt vmcnt(15)
s_nop 0
v_mfma_f32_16x16x32_bf16 v[20:23], v[136:139], v[12:15], v[20:23]
buffer_load_dwordx4 v[136:139], v1, s[4:7], s22 offen offset:2048 nt
v_and_b32_dpp v16, v30, v8 row_newbcast:3 row_mask:0xf bank_mask:0xf
v_and_b32_dpp v17, v30, v9 row_newbcast:3 row_mask:0xf bank_mask:0xf
v_and_b32_dpp v18, v30, v10 row_newbcast:3 row_mask:0xf bank_mask:0xf
v_and_b32_dpp v19, v30, v11 row_newbcast:3 row_mask:0xf bank_mask:0xf
s_waitcnt vmcnt(15)
s_nop 0
v_mfma_f32_16x16x32_bf16 v[20:23], v[140:143], v[16:19], v[20:23]
buffer_load_dwordx4 v[140:143], v1, s[4:7], s22 offen offset:3072 nt
v_and_b32_dpp v12, v30, v8 row_newbcast:4 row_mask:0xf bank_mask:0xf
v_and_b32_dpp v13, v30, v9 row_newbcast:4 row_mask:0xf bank_mask:0xf
v_and_b32_dpp v14, v30, v10 row_newbcast:4 row_mask:0xf bank_mask:0xf
v_and_b32_dpp v15, v30, v11 row_newbcast:4 row_mask:0xf bank_mask:0xf
s_waitcnt vmcnt(15)
s_nop 0
v_mfma_f32_16x16x32_bf16 v[20:23], v[144:147], v[12:15], v[20:23]
s_add_u32 s22, s52, 16384
buffer_load_dwordx4 v[144:147], v1, s[4:7], s22 offen offset:0 nt
v_and_b32_dpp v16, v30, v8 row_newbcast:5 row_mask:0xf bank_mask:0xf
v_and_b32_dpp v17, v30, v9 row_newbcast:5 row_mask:0xf bank_mask:0xf
v_and_b32_dpp v18, v30, v10 row_newbcast:5 row_mask:0xf bank_mask:0xf
v_and_b32_dpp v19, v30, v11 row_newbcast:5 row_mask:0xf bank_mask:0xf
s_waitcnt vmcnt(15)
s_nop 0
v_mfma_f32_16x16x32_bf16 v[20:23], v[148:151], v[16:19], v[20:23]
buffer_load_dwordx4 v[148:151], v1, s[4:7], s22 offen offset:1024 nt
v_and_b32_dpp v12, v30, v8 row_newbcast:6 row_mask:0xf bank_mask:0xf
v_and_b32_dpp v13, v30, v9 row_newbcast:6 row_mask:0xf bank_mask:0xf
v_and_b32_dpp v14, v30, v10 row_newbcast:6 row_mask:0xf bank_mask:0xf
v_and_b32_dpp v15, v30, v11 row_newbcast:6 row_mask:0xf bank_mask:0xf
s_waitcnt vmcnt(15)
s_nop 0
v_mfma_f32_16x16x32_bf16 v[20:23], v[152:155], v[12:15], v[20:23]
buffer_load_dwordx4 v[152:155], v1, s[4:7], s22 offen offset:2048 nt
v_and_b32_dpp v16, v30, v8 row_newbcast:7 row_mask:0xf bank_mask:0xf
v_and_b32_dpp v17, v30, v9 row_newbcast:7 row_mask:0xf bank_mask:0xf
v_and_b32_dpp v18, v30, v10 row_newbcast:7 row_mask:0xf bank_mask:0xf
v_and_b32_dpp v19, v30, v11 row_newbcast:7 row_mask:0xf bank_mask:0xf
s_waitcnt vmcnt(15)
s_nop 0
v_mfma_f32_16x16x32_bf16 v[20:23], v[156:159], v[16:19], v[20:23]
buffer_load_dwordx4 v[156:159], v1, s[4:7], s22 offen offset:3072 nt
v_and_b32_dpp v12, v30, v8 row_newbcast:8 row_mask:0xf bank_mask:0xf
v_and_b32_dpp v13, v30, v9 row_newbcast:8 row_mask:0xf bank_mask:0xf
v_and_b32_dpp v14, v30, v10 row_newbcast:8 row_mask:0xf bank_mask:0xf
v_and_b32_dpp v15, v30, v11 row_newbcast:8 row_mask:0xf bank_mask:0xf
s_waitcnt vmcnt(15)
s_nop 0
v_mfma_f32_16x16x32_bf16 v[20:23], v[160:163], v[12:15], v[20:23]
s_add_u32 s22, s52, 32768
buffer_load_dwordx4 v[160:163], v1, s[4:7], s22 offen offset:0 nt
v_and_b32_dpp v16, v30, v8 row_newbcast:9 row_mask:0xf bank_mask:0xf
v_and_b32_dpp v17, v30, v9 row_newbcast:9 row_mask:0xf bank_mask:0xf
v_and_b32_dpp v18, v30, v10 row_newbcast:9 row_mask:0xf bank_mask:0xf
v_and_b32_dpp v19, v30, v11 row_newbcast:9 row_mask:0xf bank_mask:0xf
s_waitcnt vmcnt(15)
s_nop 0
v_mfma_f32_16x16x32_bf16 v[20:23], v[164:167], v[16:19], v[20:23]
buffer_load_dwordx4 v[164:167], v1, s[4:7], s22 offen offset:1024 nt
v_and_b32_dpp v12, v30, v8 row_newbcast:10 row_mask:0xf bank_mask:0xf
v_and_b32_dpp v13, v30, v9 row_newbcast:10 row_mask:0xf bank_mask:0xf
v_and_b32_dpp v14, v30, v10 row_newbcast:10 row_mask:0xf bank_mask:0xf
v_and_b32_dpp v15, v30, v11 row_newbcast:10 row_mask:0xf bank_mask:0xf
s_waitcnt vmcnt(15)
s_nop 0
v_mfma_f32_16x16x32_bf16 v[20:23], v[168:171], v[12:15], v[20:23]
buffer_load_dwordx4 v[168:171], v1, s[4:7], s22 offen offset:2048 nt
v_and_b32_dpp v16, v30, v8 row_newbcast:11 row_mask:0xf bank_mask:0xf
v_and_b32_dpp v17, v30, v9 row_newbcast:11 row_mask:0xf bank_mask:0xf
v_and_b32_dpp v18, v30, v10 row_newbcast:11 row_mask:0xf bank_mask:0xf
v_and_b32_dpp v19, v30, v11 row_newbcast:11 row_mask:0xf bank_mask:0xf
s_waitcnt vmcnt(15)
s_nop 0
v_mfma_f32_16x16x32_bf16 v[20:23], v[172:175], v[16:19], v[20:23]
buffer_load_dwordx4 v[172:175], v1, s[4:7], s22 offen offset:3072 nt
v_and_b32_dpp v12, v30, v8 row_newbcast:12 row_mask:0xf bank_mask:0xf
v_and_b32_dpp v13, v30, v9 row_newbcast:12 row_mask:0xf bank_mask:0xf
v_and_b32_dpp v14, v30, v10 row_newbcast:12 row_mask:0xf bank_mask:0xf
v_and_b32_dpp v15, v30, v11 row_newbcast:12 row_mask:0xf bank_mask:0xf
s_waitcnt vmcnt(15)
s_nop 0
v_mfma_f32_16x16x32_bf16 v[20:23], v[176:179], v[12:15], v[20:23]
s_add_u32 s22, s52, 49152
buffer_load_dwordx4 v[176:179], v1, s[4:7], s22 offen offset:0 nt
v_and_b32_dpp v16, v30, v8 row_newbcast:13 row_mask:0xf bank_mask:0xf
v_and_b32_dpp v17, v30, v9 row_newbcast:13 row_mask:0xf bank_mask:0xf
v_and_b32_dpp v18, v30, v10 row_newbcast:13 row_mask:0xf bank_mask:0xf
v_and_b32_dpp v19, v30, v11 row_newbcast:13 row_mask:0xf bank_mask:0xf
s_waitcnt vmcnt(15)
s_nop 0
v_mfma_f32_16x16x32_bf16 v[20:23], v[180:183], v[16:19], v[20:23]
buffer_load_dwordx4 v[180:183], v1, s[4:7], s22 offen offset:1024 nt
v_and_b32_dpp v12, v30, v8 row_newbcast:14 row_mask:0xf bank_mask:0xf
v_and_b32_dpp v13, v30, v9 row_newbcast:14 row_mask:0xf bank_mask:0xf
v_and_b32_dpp v14, v30, v10 row_newbcast:14 row_mask:0xf bank_mask:0xf
v_and_b32_dpp v15, v30, v11 row_newbcast:14 row_mask:0xf bank_mask:0xf
s_waitcnt vmcnt(15)
s_nop 0
v_mfma_f32_16x16x32_bf16 v[20:23], v[184:187], v[12:15], v[20:23]
buffer_load_dwordx4 v[184:187], v1, s[4:7], s22 offen offset:2048 nt
v_and_b32_dpp v16, v30, v8 row_newbcast:15 row_mask:0xf bank_mask:0xf
v_and_b32_dpp v17, v30, v9 row_newbcast:15 row_mask:0xf bank_mask:0xf
v_and_b32_dpp v18, v30, v10 row_newbcast:15 row_mask:0xf bank_mask:0xf
v_and_b32_dpp v19, v30, v11 row_newbcast:15 row_mask:0xf bank_mask:0xf
s_waitcnt vmcnt(15)
s_nop 0
v_mfma_f32_16x16x32_bf16 v[20:23], v[188:191], v[16:19], v[20:23]
buffer_load_dwordx4 v[188:191], v1, s[4:7], s22 offen offset:3072 nt
s_add_u32 s64, s64, 1
s_add_u32 s65, s65, 1
v_mov_b32 v26, s65
ds_max_u32 v27, v26
s_cmp_lg_u32 s64, 3
s_cbranch_scc1 L_v3
v_mov_b32 v26, 1
s_mov_b64 exec, 1
ds_add_u32 v27, v26 offset:20
s_mov_b64 exec, -1
L_v3:
s_cmp_lt_u32 s64, 11
s_cbranch_scc1 L_v
L_vd:
s_waitcnt lgkmcnt(0)
s_sub_u32 s72, s72, s70
s_and_b32 s42, s72, 0xffff
s_lshr_b32 s43, s72, 16
s_add_u32 s42, s42, s43
s_cmp_ge_u32 s42, 32
s_cbranch_scc1 L_vlast
s_mov_b32 s89, s42
s_lshr_b32 s72, s72, s56
s_and_b32 s72, s72, 0xffff
s_add_u32 s72, s72, 48
s_sub_u32 s40, 127, s72
s_cmp_eq_u32 s48, 0
s_cselect_b32 s40, s72, s40
s_lshr_b32 s41, s40, 2
s_lshl_b32 s41, s41, 16
s_and_b32 s42, s40, 3
s_lshl_b32 s42, s42, 12
s_add_u32 s52, s54, s41
s_add_u32 s52, s52, s42
s_lshl_b32 s59, s40, 8
s_add_u32 s59, s59, s73
s_add_u32 s72, s70, 32
s_cmp_ge_u32 s89, s88
s_cbranch_scc1 L_noask
s_mov_b32 s72, s55
s_atomic_add s72, s[74:75], 4 glc
L_noask:
v_sub_f32 v30, v31, v24
v_mul_f32 v30, 0x3fb8aa3b, v30
v_exp_f32 v30, v30
buffer_load_dword v31, v60, s[12:15], s59 offen sc1
s_nop 0
v_add_f32 v25, v25, v30
v_cvt_pk_bf16_f32 v30, v30, v30
s_nop 1
v_and_b32_dpp v12, v30, v8 row_newbcast:0 row_mask:0xf bank_mask:0xf
v_and_b32_dpp v13, v30, v9 row_newbcast:0 row_mask:0xf bank_mask:0xf
v_and_b32_dpp v14, v30, v10 row_newbcast:0 row_mask:0xf bank_mask:0xf
v_and_b32_dpp v15, v30, v11 row_newbcast:0 row_mask:0xf bank_mask:0xf
s_waitcnt vmcnt(15)
s_nop 0
v_mfma_f32_16x16x32_bf16 v[20:23], v[128:131], v[12:15], v[20:23]
s_add_u32 s22, s52, 0
buffer_load_dwordx4 v[128:131], v1, s[4:7], s22 offen offset:0 nt
v_and_b32_dpp v16, v30, v8 row_newbcast:1 row_mask:0xf bank_mask:0xf
v_and_b32_dpp v17, v30, v9 row_newbcast:1 row_mask:0xf bank_mask:0xf
v_and_b32_dpp v18, v30, v10 row_newbcast:1 row_mask:0xf bank_mask:0xf
v_and_b32_dpp v19, v30, v11 row_newbcast:1 row_mask:0xf bank_mask:0xf
s_waitcnt vmcnt(15)
s_nop 0
v_mfma_f32_16x16x32_bf16 v[20:23], v[132:135], v[16:19], v[20:23]
buffer_load_dwordx4 v[132:135], v1, s[4:7], s22 offen offset:1024 nt
v_and_b32_dpp v12, v30, v8 row_newbcast:2 row_mask:0xf bank_mask:0xf
v_and_b32_dpp v13, v30, v9 row_newbcast:2 row_mask:0xf bank_mask:0xf
v_and_b32_dpp v14, v30, v10 row_newbcast:2 row_mask:0xf bank_mask:0xf
v_and_b32_dpp v15, v30, v11 row_newbcast:2 row_mask:0xf bank_mask:0xf
s_waitcnt vmcnt(15)
s_nop 0
v_mfma_f32_16x16x32_bf16 v[20:23], v[136:139], v[12:15], v[20:23]
buffer_load_dwordx4 v[136:139], v1, s[4:7], s22 offen offset:2048 nt
v_and_b32_dpp v16, v30, v8 row_newbcast:3 row_mask:0xf bank_mask:0xf
v_and_b32_dpp v17, v30, v9 row_newbcast:3 row_mask:0xf bank_mask:0xf
v_and_b32_dpp v18, v30, v10 row_newbcast:3 row_mask:0xf bank_mask:0xf
v_and_b32_dpp v19, v30, v11 row_newbcast:3 row_mask:0xf bank_mask:0xf
s_waitcnt vmcnt(15)
s_nop 0
v_mfma_f32_16x16x32_bf16 v[20:23], v[140:143], v[16:19], v[20:23]
buffer_load_dwordx4 v[140:143], v1, s[4:7], s22 offen offset:3072 nt
v_and_b32_dpp v12, v30, v8 row_newbcast:4 row_mask:0xf bank_mask:0xf
v_and_b32_dpp v13, v30, v9 row_newbcast:4 row_mask:0xf bank_mask:0xf
v_and_b32_dpp v14, v30, v10 row_newbcast:4 row_mask:0xf bank_mask:0xf
v_and_b32_dpp v15, v30, v11 row_newbcast:4 row_mask:0xf bank_mask:0xf
s_waitcnt vmcnt(15)
s_nop 0
v_mfma_f32_16x16x32_bf16 v[20:23], v[144:147], v[12:15], v[20:23]
s_add_u32 s22, s52, 16384
buffer_load_dwordx4 v[144:147], v1, s[4:7], s22 offen offset:0 nt
v_and_b32_dpp v16, v30, v8 row_newbcast:5 row_mask:0xf bank_mask:0xf
v_and_b32_dpp v17, v30, v9 row_newbcast:5 row_mask:0xf bank_mask:0xf
v_and_b32_dpp v18, v30, v10 row_newbcast:5 row_mask:0xf bank_mask:0xf
v_and_b32_dpp v19, v30, v11 row_newbcast:5 row_mask:0xf bank_mask:0xf
s_waitcnt vmcnt(15)
s_nop 0
v_mfma_f32_16x16x32_bf16 v[20:23], v[148:151], v[16:19], v[20:23]
buffer_load_dwordx4 v[148:151], v1, s[4:7], s22 offen offset:1024 nt
v_and_b32_dpp v12, v30, v8 row_newbcast:6 row_mask:0xf bank_mask:0xf
v_and_b32_dpp v13, v30, v9 row_newbcast:6 row_mask:0xf bank_mask:0xf
v_and_b32_dpp v14, v30, v10 row_newbcast:6 row_mask:0xf bank_mask:0xf
v_and_b32_dpp v15, v30, v11 row_newbcast:6 row_mask:0xf bank_mask:0xf
s_waitcnt vmcnt(15)
s_nop 0
v_mfma_f32_16x16x32_bf16 v[20:23], v[152:155], v[12:15], v[20:23]
buffer_load_dwordx4 v[152:155], v1, s[4:7], s22 offen offset:2048 nt
v_and_b32_dpp v16, v30, v8 row_newbcast:7 row_mask:0xf bank_mask:0xf
v_and_b32_dpp v17, v30, v9 row_newbcast:7 row_mask:0xf bank_mask:0xf
v_and_b32_dpp v18, v30, v10 row_newbcast:7 row_mask:0xf bank_mask:0xf
v_and_b32_dpp v19, v30, v11 row_newbcast:7 row_mask:0xf bank_mask:0xf
s_waitcnt vmcnt(15)
s_nop 0
v_mfma_f32_16x16x32_bf16 v[20:23], v[156:159], v[16:19], v[20:23]
buffer_load_dwordx4 v[156:159], v1, s[4:7], s22 offen offset:3072 nt
v_and_b32_dpp v12, v30, v8 row_newbcast:8 row_mask:0xf bank_mask:0xf
v_and_b32_dpp v13, v30, v9 row_newbcast:8 row_mask:0xf bank_mask:0xf
v_and_b32_dpp v14, v30, v10 row_newbcast:8 row_mask:0xf bank_mask:0xf
v_and_b32_dpp v15, v30, v11 row_newbcast:8 row_mask:0xf bank_mask:0xf
s_waitcnt vmcnt(15)
s_nop 0
v_mfma_f32_16x16x32_bf16 v[20:23], v[160:163], v[12:15], v[20:23]
s_add_u32 s22, s52, 32768
buffer_load_dwordx4 v[160:163], v1, s[4:7], s22 offen offset:0 nt
v_and_b32_dpp v16, v30, v8 row_newbcast:9 row_mask:0xf bank_mask:0xf
v_and_b32_dpp v17, v30, v9 row_newbcast:9 row_mask:0xf bank_mask:0xf
v_and_b32_dpp v18, v30, v10 row_newbcast:9 row_mask:0xf bank_mask:0xf
v_and_b32_dpp v19, v30, v11 row_newbcast:9 row_mask:0xf bank_mask:0xf
s_waitcnt vmcnt(15)
s_nop 0
v_mfma_f32_16x16x32_bf16 v[20:23], v[164:167], v[16:19], v[20:23]
buffer_load_dwordx4 v[164:167], v1, s[4:7], s22 offen offset:1024 nt
v_and_b32_dpp v12, v30, v8 row_newbcast:10 row_mask:0xf bank_mask:0xf
v_and_b32_dpp v13, v30, v9 row_newbcast:10 row_mask:0xf bank_mask:0xf
v_and_b32_dpp v14, v30, v10 row_newbcast:10 row_mask:0xf bank_mask:0xf
v_and_b32_dpp v15, v30, v11 row_newbcast:10 row_mask:0xf bank_mask:0xf
s_waitcnt vmcnt(15)
s_nop 0
v_mfma_f32_16x16x32_bf16 v[20:23], v[168:171], v[12:15], v[20:23]
buffer_load_dwordx4 v[168:171], v1, s[4:7], s22 offen offset:2048 nt
v_and_b32_dpp v16, v30, v8 row_newbcast:11 row_mask:0xf bank_mask:0xf
v_and_b32_dpp v17, v30, v9 row_newbcast:11 row_mask:0xf bank_mask:0xf
v_and_b32_dpp v18, v30, v10 row_newbcast:11 row_mask:0xf bank_mask:0xf
v_and_b32_dpp v19, v30, v11 row_newbcast:11 row_mask:0xf bank_mask:0xf
s_waitcnt vmcnt(15)
s_nop 0
v_mfma_f32_16x16x32_bf16 v[20:23], v[172:175], v[16:19], v[20:23]
buffer_load_dwordx4 v[172:175], v1, s[4:7], s22 offen offset:3072 nt
v_and_b32_dpp v12, v30, v8 row_newbcast:12 row_mask:0xf bank_mask:0xf
v_and_b32_dpp v13, v30, v9 row_newbcast:12 row_mask:0xf bank_mask:0xf
v_and_b32_dpp v14, v30, v10 row_newbcast:12 row_mask:0xf bank_mask:0xf
v_and_b32_dpp v15, v30, v11 row_newbcast:12 row_mask:0xf bank_mask:0xf
s_waitcnt vmcnt(15)
s_nop 0
v_mfma_f32_16x16x32_bf16 v[20:23], v[176:179], v[12:15], v[20:23]
s_add_u32 s22, s52, 49152
buffer_load_dwordx4 v[176:179], v1, s[4:7], s22 offen offset:0 nt
v_and_b32_dpp v16, v30, v8 row_newbcast:13 row_mask:0xf bank_mask:0xf
v_and_b32_dpp v17, v30, v9 row_newbcast:13 row_mask:0xf bank_mask:0xf
v_and_b32_dpp v18, v30, v10 row_newbcast:13 row_mask:0xf bank_mask:0xf
v_and_b32_dpp v19, v30, v11 row_newbcast:13 row_mask:0xf bank_mask:0xf
s_waitcnt vmcnt(15)
s_nop 0
v_mfma_f32_16x16x32_bf16 v[20:23], v[180:183], v[16:19], v[20:23]
buffer_load_dwordx4 v[180:183], v1, s[4:7], s22 offen offset:1024 nt
v_and_b32_dpp v12, v30, v8 row_newbcast:14 row_mask:0xf bank_mask:0xf
v_and_b32_dpp v13, v30, v9 row_newbcast:14 row_mask:0xf bank_mask:0xf
v_and_b32_dpp v14, v30, v10 row_newbcast:14 row_mask:0xf bank_mask:0xf
v_and_b32_dpp v15, v30, v11 row_newbcast:14 row_mask:0xf bank_mask:0xf
s_waitcnt vmcnt(15)
s_nop 0
v_mfma_f32_16x16x32_bf16 v[20:23], v[184:187], v[12:15], v[20:23]
buffer_load_dwordx4 v[184:187], v1, s[4:7], s22 offen offset:2048 nt
v_and_b32_dpp v16, v30, v8 row_newbcast:15 row_mask:0xf bank_mask:0xf
v_and_b32_dpp v17, v30, v9 row_newbcast:15 row_mask:0xf bank_mask:0xf
v_and_b32_dpp v18, v30, v10 row_newbcast:15 row_mask:0xf bank_mask:0xf
v_and_b32_dpp v19, v30, v11 row_newbcast:15 row_mask:0xf bank_mask:0xf
s_waitcnt vmcnt(15)
s_nop 0
v_mfma_f32_16x16x32_bf16 v[20:23], v[188:191], v[16:19], v[20:23]
buffer_load_dwordx4 v[188:191], v1, s[4:7], s22 offen offset:3072 nt
s_waitcnt vmcnt(16)
s_branch L_vd
L_vlast:
s_mov_b32 s86, 0
s_cmp_lg_u32 s87, 0
s_cbranch_scc1 L_nosib
ds_read_b128 v[48:51], v61 offset:32
s_waitcnt lgkmcnt(0)
v_readfirstlane_b32 s40, v48
v_readfirstlane_b32 s70, v50
s_cmp_eq_u32 s40, 0
s_cbranch_scc1 L_nosib
s_xor_b32 s74, s74, 256
s_xor_b32 s54, s54, 0x200000
s_xor_b32 s73, s73, 0x8000
s_mov_b32 s72, s55
s_atomic_add s72, s[74:75], 4 glc
s_mov_b32 s86, 1
L_nosib:
v_sub_f32 v30, v31, v24
v_mul_f32 v30, 0x3fb8aa3b, v30
v_exp_f32 v30, v30
s_nop 0
v_add_f32 v25, v25, v30
v_cvt_pk_bf16_f32 v30, v30, v30
s_nop 1
v_and_b32_dpp v12, v30, v8 row_newbcast:0 row_mask:0xf bank_mask:0xf
v_and_b32_dpp v13, v30, v9 row_newbcast:0 row_mask:0xf bank_mask:0xf
v_and_b32_dpp v14, v30, v10 row_newbcast:0 row_mask:0xf bank_mask:0xf
v_and_b32_dpp v15, v30, v11 row_newbcast:0 row_mask:0xf bank_mask:0xf
s_waitcnt vmcnt(15)
s_nop 0
v_mfma_f32_16x16x32_bf16 v[20:23], v[128:131], v[12:15], v[20:23]
v_and_b32_dpp v16, v30, v8 row_newbcast:1 row_mask:0xf bank_mask:0xf
v_and_b32_dpp v17, v30, v9 row_newbcast:1 row_mask:0xf bank_mask:0xf
v_and_b32_dpp v18, v30, v10 row_newbcast:1 row_mask:0xf bank_mask:0xf
v_and_b32_dpp v19, v30, v11 row_newbcast:1 row_mask:0xf bank_mask:0xf
s_waitcnt vmcnt(14)
s_nop 0
v_mfma_f32_16x16x32_bf16 v[20:23], v[132:135], v[16:19], v[20:23]
v_and_b32_dpp v12, v30, v8 row_newbcast:2 row_mask:0xf bank_mask:0xf
v_and_b32_dpp v13, v30, v9 row_newbcast:2 row_mask:0xf bank_mask:0xf
v_and_b32_dpp v14, v30, v10 row_newbcast:2 row_mask:0xf bank_mask:0xf
v_and_b32_dpp v15, v30, v11 row_newbcast:2 row_mask:0xf bank_mask:0xf
s_waitcnt vmcnt(13)
s_nop 0
v_mfma_f32_16x16x32_bf16 v[20:23], v[136:139], v[12:15], v[20:23]
v_and_b32_dpp v16, v30, v8 row_newbcast:3 row_mask:0xf bank_mask:0xf
v_and_b32_dpp v17, v30, v9 row_newbcast:3 row_mask:0xf bank_mask:0xf
v_and_b32_dpp v18, v30, v10 row_newbcast:3 row_mask:0xf bank_mask:0xf
v_and_b32_dpp v19, v30, v11 row_newbcast:3 row_mask:0xf bank_mask:0xf
s_waitcnt vmcnt(12)
s_nop 0
v_mfma_f32_16x16x32_bf16 v[20:23], v[140:143], v[16:19], v[20:23]
v_and_b32_dpp v12, v30, v8 row_newbcast:4 row_mask:0xf bank_mask:0xf
v_and_b32_dpp v13, v30, v9 row_newbcast:4 row_mask:0xf bank_mask:0xf
v_and_b32_dpp v14, v30, v10 row_newbcast:4 row_mask:0xf bank_mask:0xf
v_and_b32_dpp v15, v30, v11 row_newbcast:4 row_mask:0xf bank_mask:0xf
s_waitcnt vmcnt(11)
s_nop 0
v_mfma_f32_16x16x32_bf16 v[20:23], v[144:147], v[12:15], v[20:23]
v_and_b32_dpp v16, v30, v8 row_newbcast:5 row_mask:0xf bank_mask:0xf
v_and_b32_dpp v17, v30, v9 row_newbcast:5 row_mask:0xf bank_mask:0xf
v_and_b32_dpp v18, v30, v10 row_newbcast:5 row_mask:0xf bank_mask:0xf
v_and_b32_dpp v19, v30, v11 row_newbcast:5 row_mask:0xf bank_mask:0xf
s_waitcnt vmcnt(10)
s_nop 0
v_mfma_f32_16x16x32_bf16 v[20:23], v[148:151], v[16:19], v[20:23]
v_and_b32_dpp v12, v30, v8 row_newbcast:6 row_mask:0xf bank_mask:0xf
v_and_b32_dpp v13, v30, v9 row_newbcast:6 row_mask:0xf bank_mask:0xf
v_and_b32_dpp v14, v30, v10 row_newbcast:6 row_mask:0xf bank_mask:0xf
v_and_b32_dpp v15, v30, v11 row_newbcast:6 row_mask:0xf bank_mask:0xf
s_waitcnt vmcnt(9)
s_nop 0
v_mfma_f32_16x16x32_bf16 v[20:23], v[152:155], v[12:15], v[20:23]
v_and_b32_dpp v16, v30, v8 row_newbcast:7 row_mask:0xf bank_mask:0xf
v_and_b32_dpp v17, v30, v9 row_newbcast:7 row_mask:0xf bank_mask:0xf
v_and_b32_dpp v18, v30, v10 row_newbcast:7 row_mask:0xf bank_mask:0xf
v_and_b32_dpp v19, v30, v11 row_newbcast:7 row_mask:0xf bank_mask:0xf
s_waitcnt vmcnt(8)
s_nop 0
v_mfma_f32_16x16x32_bf16 v[20:23], v[156:159], v[16:19], v[20:23]
v_and_b32_dpp v12, v30, v8 row_newbcast:8 row_mask:0xf bank_mask:0xf
v_and_b32_dpp v13, v30, v9 row_newbcast:8 row_mask:0xf bank_mask:0xf
v_and_b32_dpp v14, v30, v10 row_newbcast:8 row_mask:0xf bank_mask:0xf
v_and_b32_dpp v15, v30, v11 row_newbcast:8 row_mask:0xf bank_mask:0xf
s_waitcnt vmcnt(7)
s_nop 0
v_mfma_f32_16x16x32_bf16 v[20:23], v[160:163], v[12:15], v[20:23]
v_and_b32_dpp v16, v30, v8 row_newbcast:9 row_mask:0xf bank_mask:0xf
v_and_b32_dpp v17, v30, v9 row_newbcast:9 row_mask:0xf bank_mask:0xf
v_and_b32_dpp v18, v30, v10 row_newbcast:9 row_mask:0xf bank_mask:0xf
v_and_b32_dpp v19, v30, v11 row_newbcast:9 row_mask:0xf bank_mask:0xf
s_waitcnt vmcnt(6)
s_nop 0
v_mfma_f32_16x16x32_bf16 v[20:23], v[164:167], v[16:19], v[20:23]
v_and_b32_dpp v12, v30, v8 row_newbcast:10 row_mask:0xf bank_mask:0xf
v_and_b32_dpp v13, v30, v9 row_newbcast:10 row_mask:0xf bank_mask:0xf
v_and_b32_dpp v14, v30, v10 row_newbcast:10 row_mask:0xf bank_mask:0xf
v_and_b32_dpp v15, v30, v11 row_newbcast:10 row_mask:0xf bank_mask:0xf
s_waitcnt vmcnt(5)
s_nop 0
v_mfma_f32_16x16x32_bf16 v[20:23], v[168:171], v[12:15], v[20:23]
v_and_b32_dpp v16, v30, v8 row_newbcast:11 row_mask:0xf bank_mask:0xf
v_and_b32_dpp v17, v30, v9 row_newbcast:11 row_mask:0xf bank_mask:0xf
v_and_b32_dpp v18, v30, v10 row_newbcast:11 row_mask:0xf bank_mask:0xf
v_and_b32_dpp v19, v30, v11 row_newbcast:11 row_mask:0xf bank_mask:0xf
s_waitcnt vmcnt(4)
s_nop 0
v_mfma_f32_16x16x32_bf16 v[20:23], v[172:175], v[16:19], v[20:23]
v_and_b32_dpp v12, v30, v8 row_newbcast:12 row_mask:0xf bank_mask:0xf
v_and_b32_dpp v13, v30, v9 row_newbcast:12 row_mask:0xf bank_mask:0xf
v_and_b32_dpp v14, v30, v10 row_newbcast:12 row_mask:0xf bank_mask:0xf
v_and_b32_dpp v15, v30, v11 row_newbcast:12 row_mask:0xf bank_mask:0xf
s_waitcnt vmcnt(3)
s_nop 0
v_mfma_f32_16x16x32_bf16 v[20:23], v[176:179], v[12:15], v[20:23]
v_and_b32_dpp v16, v30, v8 row_newbcast:13 row_mask:0xf bank_mask:0xf
v_and_b32_dpp v17, v30, v9 row_newbcast:13 row_mask:0xf bank_mask:0xf
v_and_b32_dpp v18, v30, v10 row_newbcast:13 row_mask:0xf bank_mask:0xf
v_and_b32_dpp v19, v30, v11 row_newbcast:13 row_mask:0xf bank_mask:0xf
s_waitcnt vmcnt(2)
s_nop 0
v_mfma_f32_16x16x32_bf16 v[20:23], v[180:183], v[16:19], v[20:23]
v_and_b32_dpp v12, v30, v8 row_newbcast:14 row_mask:0xf bank_mask:0xf
v_and_b32_dpp v13, v30, v9 row_newbcast:14 row_mask:0xf bank_mask:0xf
v_and_b32_dpp v14, v30, v10 row_newbcast:14 row_mask:0xf bank_mask:0xf
v_and_b32_dpp v15, v30, v11 row_newbcast:14 row_mask:0xf bank_mask:0xf
s_waitcnt vmcnt(1)
s_nop 0
v_mfma_f32_16x16x32_bf16 v[20:23], v[184:187], v[12:15], v[20:23]
v_and_b32_dpp v16, v30, v8 row_newbcast:15 row_mask:0xf bank_mask:0xf
v_and_b32_dpp v17, v30, v9 row_newbcast:15 row_mask:0xf bank_mask:0xf
v_and_b32_dpp v18, v30, v10 row_newbcast:15 row_mask:0xf bank_mask:0xf
v_and_b32_dpp v19, v30, v11 row_newbcast:15 row_mask:0xf bank_mask:0xf
s_waitcnt vmcnt(0)
s_nop 0
v_mfma_f32_16x16x32_bf16 v[20:23], v[188:191], v[16:19], v[20:23]
s_nop 1
v_add_f32_dpp v25, v25, v25 quad_perm:[1,0,3,2] row_mask:0xf bank_mask:0xf
s_nop 1
v_add_f32_dpp v25, v25, v25 quad_perm:[2,3,0,1] row_mask:0xf bank_mask:0xf
s_nop 1
v_add_f32_dpp v25, v25, v25 row_half_mirror row_mask:0xf bank_mask:0xf
s_nop 1
v_add_f32_dpp v25, v25, v25 row_mirror row_mask:0xf bank_mask:0xf
s_nop 1
v_mov_b32 v29, v25
s_nop 1
v_permlane16_swap_b32 v25, v29
s_nop 1
v_add_f32 v25, v25, v29
v_mov_b32 v29, v25
s_nop 1
v_permlane32_swap_b32 v25, v29
s_nop 1
v_add_f32 v25, v25, v29
ds_write_b32 v56, v20 offset:0
ds_write_b32 v56, v21 offset:32
ds_write_b32 v56, v22 offset:64
ds_write_b32 v56, v23 offset:96
ds_write_b64 v57, v[24:25]
s_cmp_eq_u32 s86, 0
s_cbranch_scc1 L_done
s_waitcnt lgkmcnt(0)
s_sub_u32 s72, s72, s70
s_and_b32 s42, s72, 0xffff
s_lshr_b32 s43, s72, 16
s_add_u32 s42, s42, s43
s_cmp_ge_u32 s42, 32
s_cbranch_scc1 L_done
s_lshr_b32 s72, s72, s56
s_and_b32 s72, s72, 0xffff
s_add_u32 s72, s72, 48
s_sub_u32 s40, 127, s72
s_cmp_eq_u32 s48, 0
s_cselect_b32 s40, s72, s40
s_lshr_b32 s41, s40, 2
s_lshl_b32 s41, s41, 16
s_and_b32 s42, s40, 3
s_lshl_b32 s42, s42, 12
s_add_u32 s52, s54, s41
s_add_u32 s52, s52, s42
s_lshl_b32 s59, s40, 8
s_add_u32 s59, s59, s73
buffer_load_dword v31, v60, s[12:15], s59 offen sc1
s_add_u32 s22, s52, 0
buffer_load_dwordx4 v[128:131], v1, s[4:7], s22 offen offset:0 nt
buffer_load_dwordx4 v[132:135], v1, s[4:7], s22 offen offset:1024 nt
buffer_load_dwordx4 v[136:139], v1, s[4:7], s22 offen offset:2048 nt
buffer_load_dwordx4 v[140:143], v1, s[4:7], s22 offen offset:3072 nt
s_add_u32 s22, s52, 16384
buffer_load_dwordx4 v[144:147], v1, s[4:7], s22 offen offset:0 nt
buffer_load_dwordx4 v[148:151], v1, s[4:7], s22 offen offset:1024 nt
buffer_load_dwordx4 v[152:155], v1, s[4:7], s22 offen offset:2048 nt
buffer_load_dwordx4 v[156:159], v1, s[4:7], s22 offen offset:3072 nt
s_add_u32 s22, s52, 32768
buffer_load_dwordx4 v[160:163], v1, s[4:7], s22 offen offset:0 nt
buffer_load_dwordx4 v[164:167], v1, s[4:7], s22 offen offset:1024 nt
buffer_load_dwordx4 v[168:171], v1, s[4:7], s22 offen offset:2048 nt
buffer_load_dwordx4 v[172:175], v1, s[4:7], s22 offen offset:3072 nt
s_add_u32 s22, s52, 49152
buffer_load_dwordx4 v[176:179], v1, s[4:7], s22 offen offset:0 nt
buffer_load_dwordx4 v[180:183], v1, s[4:7], s22 offen offset:1024 nt
buffer_load_dwordx4 v[184:187], v1, s[4:7], s22 offen offset:2048 nt
buffer_load_dwordx4 v[188:191], v1, s[4:7], s22 offen offset:3072 nt
s_mov_b32 s87, 1
v_add_u32 v56, 11392, v56
v_add_u32 v57, 11392, v57
s_mov_b32 s72, s55
s_atomic_add s72, s[74:75], 4 glc
v_mov_b32 v20, 0
v_mov_b32 v21, 0
v_mov_b32 v22, 0
v_mov_b32 v23, 0
v_mov_b32 v24, v49
v_mov_b32 v25, 0
s_waitcnt vmcnt(16)
s_branch L_vd
L_done:
v_mov_b32 v26, 1
s_mov_b64 exec, 1
s_waitcnt lgkmcnt(0)
ds_add_u32 v27, v26 offset:16
s_mov_b64 exec, -1
L_sfin:
s_endpgm
L_helper:
s_sub_u32 s3, s3, 4
s_setprio 3
s_lshl_b32 s58, s50, 1
s_add_u32 s58, s58, s48
v_lshlrev_b32 v26, 13, v2
v_lshl_add_u32 v26, v3, 4, v26
v_mov_b32 v20, 0
v_mov_b32 v21, 0
v_mov_b32 v22, 0
v_mov_b32 v23, 0
v_mov_b32 v28, 14368
ds_write_b128 v28, v[20:23]
ds_write_b128 v28, v[20:23] offset:16
s_lshl_b32 s40, s49, 8
s_lshl_b32 s41, s58, 19
s_add_u32 s40, s40, s41
s_lshl_b32 s41, s3, 17
s_add_u32 s40, s40, s41
s_lshl_b32 s41, s3, 10
s_waitcnt lgkmcnt(0)
s_mov_b32 s16, s20
s_mov_b32 s17, s21
s_mov_b32 s18, 0x1000
s_mov_b32 s19, 0x20000
buffer_load_dwordx4 v[48:51], v1, s[16:19], s41 offen
s_mov_b32 s16, s24
s_mov_b32 s17, s25
s_mov_b32 s18, 0x400000
s_mov_b32 s19, 0x20000
buffer_load_dwordx4 v[64:67], v26, s[16:19], s40 offen
s_add_u32 s40, s40, 0x8000
buffer_load_dwordx4 v[68:71], v26, s[16:19], s40 offen
s_add_u32 s40, s40, 0x8000
buffer_load_dwordx4 v[72:75], v26, s[16:19], s40 offen
s_add_u32 s40, s40, 0x8000
buffer_load_dwordx4 v[76:79], v26, s[16:19], s40 offen
s_add_u32 s40, s40, 0x8000
s_barrier
s_mov_b32 s12, s46
s_mov_b32 s13, s47
s_mov_b32 s14, 0x40000000
s_mov_b32 s15, 0x20000
s_lshl_b32 s42, s49, 8
s_add_u32 s76, s42, 2621440
s_add_u32 s42, s46, s76
s_addc_u32 s43, s47, 0
s_load_dwordx2 s[56:57], s[42:43], 0 glc
s_xor_b32 s42, s42, 256
s_load_dwordx2 s[82:83], s[42:43], 0 glc
s_lshl_b32 s42, s51, 8
s_add_u32 s42, s42, 2686976
s_add_u32 s42, s46, s42
s_addc_u32 s43, s47, 0
s_mov_b32 s72, 0
s_mov_b32 s73, 0
s_cmp_lg_u32 s3, s50
s_cbranch_scc1 L_nobase
s_load_dwordx2 s[72:73], s[42:43], 0 glc
L_nobase:
v_mov_b32 v8, 0
v_mov_b32 v28, 0xffff
v_cmp_eq_u32 vcc, 0, v3
s_nop 1
v_cndmask_b32 v8, v8, v28, vcc
v_mov_b32 v28, 0xffff0000
v_cmp_eq_u32 vcc, 1, v3
s_nop 1
v_cndmask_b32 v8, v8, v28, vcc
v_mov_b32 v9, 0
v_mov_b32 v28, 0xffff
v_cmp_eq_u32 vcc, 2, v3
s_nop 1
v_cndmask_b32 v9, v9, v28, vcc
v_mov_b32 v28, 0xffff0000
v_cmp_eq_u32 vcc, 3, v3
s_nop 1
v_cndmask_b32 v9, v9, v28, vcc
v_mov_b32 v10, 0
v_mov_b32 v28, 0xffff
v_cmp_eq_u32 vcc, 4, v3
s_nop 1
v_cndmask_b32 v10, v10, v28, vcc
v_mov_b32 v28, 0xffff0000
v_cmp_eq_u32 vcc, 5, v3
s_nop 1
v_cndmask_b32 v10, v10, v28, vcc
v_mov_b32 v11, 0
v_mov_b32 v28, 0xffff
v_cmp_eq_u32 vcc, 6, v3
s_nop 1
v_cndmask_b32 v11, v11, v28, vcc
v_mov_b32 v28, 0xffff0000
v_cmp_eq_u32 vcc, 7, v3
s_nop 1
v_cndmask_b32 v11, v11, v28, vcc
s_lshl_b32 s67, s3, 12
s_add_u32 s67, s67, 44224
v_add_u32 v24, s67, v1
v_mov_b32 v28, 14368
s_mov_b32 s62, 0x01000100
s_mov_b32 s63, 0x03020302
s_lshl_b32 s40, s3, 11
v_lshlrev_b32 v58, 1, v1
v_add_u32 v58, s40, v58
s_lshl_b32 s41, s58, 8
s_add_u32 s40, s40, s41
v_lshlrev_b32 v59, 4, v3
v_lshl_add_u32 v59, v2, 2, v59
v_add_u32 v59, s40, v59
s_waitcnt vmcnt(4)
v_lshlrev_b32 v40, 16, v48
v_and_b32 v41, 0xffff0000, v48
v_lshlrev_b32 v42, 16, v49
v_and_b32 v43, 0xffff0000, v49
v_lshlrev_b32 v44, 16, v50
v_and_b32 v45, 0xffff0000, v50
v_lshlrev_b32 v46, 16, v51
v_and_b32 v47, 0xffff0000, v51
v_readfirstlane_b32 s40, v40
s_nop 1
v_subrev_f32 v52, s40, v40
v_mul_f32 v53, v52, v52
v_subrev_f32 v56, s40, v41
v_add_f32 v52, v52, v56
v_fmac_f32 v53, v56, v56
v_subrev_f32 v56, s40, v42
v_add_f32 v52, v52, v56
v_fmac_f32 v53, v56, v56
v_subrev_f32 v56, s40, v43
v_add_f32 v52, v52, v56
v_fmac_f32 v53, v56, v56
v_subrev_f32 v56, s40, v44
v_add_f32 v52, v52, v56
v_fmac_f32 v53, v56, v56
v_subrev_f32 v56, s40, v45
v_add_f32 v52, v52, v56
v_fmac_f32 v53, v56, v56
v_subrev_f32 v56, s40, v46
v_add_f32 v52, v52, v56
v_fmac_f32 v53, v56, v56
v_subrev_f32 v56, s40, v47
v_add_f32 v52, v52, v56
v_fmac_f32 v53, v56, v56
s_nop 0
v_add_f32_dpp v52, v52, v52 quad_perm:[1,0,3,2] row_mask:0xf bank_mask:0xf
v_add_f32_dpp v53, v53, v53 quad_perm:[1,0,3,2] row_mask:0xf bank_mask:0xf
s_nop 0
v_add_f32_dpp v52, v52, v52 quad_perm:[2,3,0,1] row_mask:0xf bank_mask:0xf
v_add_f32_dpp v53, v53, v53 quad_perm:[2,3,0,1] row_mask:0xf bank_mask:0xf
s_nop 0
v_add_f32_dpp v52, v52, v52 row_half_mirror row_mask:0xf bank_mask:0xf
v_add_f32_dpp v53, v53, v53 row_half_mirror row_mask:0xf bank_mask:0xf
s_nop 0
v_add_f32_dpp v52, v52, v52 row_mirror row_mask:0xf bank_mask:0xf
v_add_f32_dpp v53, v53, v53 row_mirror row_mask:0xf bank_mask:0xf
s_nop 0
v_mov_b32 v54, v52
v_mov_b32 v55, v53
s_nop 0
v_permlane16_swap_b32 v52, v54
v_permlane16_swap_b32 v53, v55
s_nop 0
v_add_f32 v52, v52, v54
v_add_f32 v53, v53, v55
v_mov_b32 v54, v52
v_mov_b32 v55, v53
s_nop 0
v_permlane32_swap_b32 v52, v54
v_permlane32_swap_b32 v53, v55
s_nop 0
v_add_f32 v52, v52, v54
v_add_f32 v53, v53, v55
v_mul_f32 v52, 0x3b000000, v52
v_mul_f32 v53, 0x3b000000, v53
v_fma_f32 v53, -v52, v52, v53
v_max_f32 v53, 0, v53
v_add_f32 v52, s40, v52
v_cvt_pk_bf16_f32 v53, v53, v53
v_lshlrev_b32 v53, 16, v53
v_cvt_pk_bf16_f32 v52, v52, v52
v_lshlrev_b32 v52, 16, v52
v_add_f32 v53, 0x3727c5ac, v53
v_cvt_pk_bf16_f32 v53, v53, v53
v_lshlrev_b32 v53, 16, v53
v_sqrt_f32 v53, v53
v_sub_f32 v40, v40, v52
v_sub_f32 v41, v41, v52
v_sub_f32 v42, v42, v52
v_sub_f32 v43, v43, v52
v_sub_f32 v44, v44, v52
v_sub_f32 v45, v45, v52
v_sub_f32 v46, v46, v52
v_sub_f32 v47, v47, v52
v_cvt_pk_bf16_f32 v53, v53, v53
v_lshlrev_b32 v53, 16, v53
v_rcp_f32 v53, v53
v_cvt_pk_bf16_f32 v40, v40, v41
v_cvt_pk_bf16_f32 v42, v42, v43
v_cvt_pk_bf16_f32 v44, v44, v45
v_cvt_pk_bf16_f32 v46, v46, v47
v_and_b32 v41, 0xffff0000, v40
v_lshlrev_b32 v40, 16, v40
v_and_b32 v43, 0xffff0000, v42
v_lshlrev_b32 v42, 16, v42
v_and_b32 v45, 0xffff0000, v44
v_lshlrev_b32 v44, 16, v44
v_and_b32 v47, 0xffff0000, v46
v_lshlrev_b32 v46, 16, v46
v_mul_f32 v40, v40, v53
v_mul_f32 v41, v41, v53
v_mul_f32 v42, v42, v53
v_mul_f32 v43, v43, v53
v_mul_f32 v44, v44, v53
v_mul_f32 v45, v45, v53
v_mul_f32 v46, v46, v53
v_mul_f32 v47, v47, v53
v_cvt_pk_bf16_f32 v40, v40, v41
v_cvt_pk_bf16_f32 v41, v42, v43
v_cvt_pk_bf16_f32 v42, v44, v45
v_cvt_pk_bf16_f32 v43, v46, v47
v_perm_b32 v47, v43, v43, s63
v_perm_b32 v46, v43, v43, s62
v_perm_b32 v45, v42, v42, s63
v_perm_b32 v44, v42, v42, s62
v_perm_b32 v43, v41, v41, s63
v_perm_b32 v42, v41, v41, s62
v_perm_b32 v41, v40, v40, s63
v_perm_b32 v40, v40, v40, s62
ds_write_b128 v58, v[40:43] offset:0
ds_write_b128 v58, v[44:47] offset:16
s_waitcnt vmcnt(3)
ds_write_b128 v24, v[64:67] offset:0
s_waitcnt vmcnt(2)
ds_write_b128 v24, v[68:71] offset:1024
s_waitcnt vmcnt(1)
ds_write_b128 v24, v[72:75] offset:2048
s_waitcnt vmcnt(0)
ds_write_b128 v24, v[76:79] offset:3072
v_mov_b32 v28, 14368
v_mov_b32 v29, 1
s_mov_b64 exec, 1
s_waitcnt lgkmcnt(0)
ds_add_u32 v28, v29 offset:12
L_gs_1:
ds_read_b32 v29, v28 offset:12
s_waitcnt lgkmcnt(0)
v_readfirstlane_b32 s43, v29
s_cmp_lt_u32 s43, 4
s_cbranch_scc1 L_gs_1
s_mov_b64 exec, -1
ds_read_b32 v53, v59 offset:0
ds_read_b128 v[64:67], v1 offset:44224
ds_read_b128 v[68:71], v1 offset:45248
ds_read_b128 v[72:75], v1 offset:46272
ds_read_b128 v[76:79], v1 offset:47296
ds_read_b128 v[80:83], v1 offset:48320
ds_read_b128 v[84:87], v1 offset:49344
ds_read_b128 v[88:91], v1 offset:50368
ds_read_b128 v[92:95], v1 offset:51392
ds_read_b128 v[96:99], v1 offset:52416
ds_read_b128 v[100:103], v1 offset:53440
ds_read_b128 v[104:107], v1 offset:54464
ds_read_b128 v[108:111], v1 offset:55488
ds_read_b128 v[112:115], v1 offset:56512
ds_read_b128 v[116:119], v1 offset:57536
ds_read_b128 v[120:123], v1 offset:58560
ds_read_b128 v[124:127], v1 offset:59584
s_cmp_lg_u32 s3, s50
s_cbranch_scc1 L_nobase2
v_mov_b32 v44, s72
v_mov_b32 v45, s73
v_mov_b32 v46, 0
v_mov_b32 v47, 0
v_mov_b32 v54, 19584
ds_write_b128 v54, v[44:47]
ds_write_b32 v54, v46 offset:32
s_waitcnt lgkmcnt(0)
L_nobase2:
s_add_u32 s56, s56, 1
s_addc_u32 s57, s57, 0
v_mov_b32 v42, s56
v_mov_b32 v43, s57
v_mov_b32 v46, s56
v_mov_b32 v47, s57
s_lshl_b32 s40, s49, 2
s_add_u32 s40, s40, s3
s_lshl_b32 s40, s40, 3
s_add_u32 s40, s40, s58
s_lshl_b32 s40, s40, 10
s_add_u32 s40, s40, 1572864
v_lshlrev_b32 v52, 8, v2
v_lshl_add_u32 v52, v3, 4, v52
s_waitcnt lgkmcnt(15)
v_and_b32_dpp v12, v53, v8 row_newbcast:0 row_mask:0xf bank_mask:0xf
v_and_b32_dpp v13, v53, v9 row_newbcast:0 row_mask:0xf bank_mask:0xf
v_and_b32_dpp v14, v53, v10 row_newbcast:0 row_mask:0xf bank_mask:0xf
v_and_b32_dpp v15, v53, v11 row_newbcast:0 row_mask:0xf bank_mask:0xf
s_waitcnt lgkmcnt(15)
s_nop 0
v_mfma_f32_16x16x32_bf16 v[20:23], v[64:67], v[12:15], v[20:23]
v_and_b32_dpp v16, v53, v8 row_newbcast:1 row_mask:0xf bank_mask:0xf
v_and_b32_dpp v17, v53, v9 row_newbcast:1 row_mask:0xf bank_mask:0xf
v_and_b32_dpp v18, v53, v10 row_newbcast:1 row_mask:0xf bank_mask:0xf
v_and_b32_dpp v19, v53, v11 row_newbcast:1 row_mask:0xf bank_mask:0xf
s_waitcnt lgkmcnt(14)
s_nop 0
v_mfma_f32_16x16x32_bf16 v[20:23], v[68:71], v[16:19], v[20:23]
v_and_b32_dpp v12, v53, v8 row_newbcast:2 row_mask:0xf bank_mask:0xf
v_and_b32_dpp v13, v53, v9 row_newbcast:2 row_mask:0xf bank_mask:0xf
v_and_b32_dpp v14, v53, v10 row_newbcast:2 row_mask:0xf bank_mask:0xf
v_and_b32_dpp v15, v53, v11 row_newbcast:2 row_mask:0xf bank_mask:0xf
s_waitcnt lgkmcnt(13)
s_nop 0
v_mfma_f32_16x16x32_bf16 v[20:23], v[72:75], v[12:15], v[20:23]
v_and_b32_dpp v16, v53, v8 row_newbcast:3 row_mask:0xf bank_mask:0xf
v_and_b32_dpp v17, v53, v9 row_newbcast:3 row_mask:0xf bank_mask:0xf
v_and_b32_dpp v18, v53, v10 row_newbcast:3 row_mask:0xf bank_mask:0xf
v_and_b32_dpp v19, v53, v11 row_newbcast:3 row_mask:0xf bank_mask:0xf
s_waitcnt lgkmcnt(12)
s_nop 0
v_mfma_f32_16x16x32_bf16 v[20:23], v[76:79], v[16:19], v[20:23]
v_and_b32_dpp v12, v53, v8 row_newbcast:4 row_mask:0xf bank_mask:0xf
v_and_b32_dpp v13, v53, v9 row_newbcast:4 row_mask:0xf bank_mask:0xf
v_and_b32_dpp v14, v53, v10 row_newbcast:4 row_mask:0xf bank_mask:0xf
v_and_b32_dpp v15, v53, v11 row_newbcast:4 row_mask:0xf bank_mask:0xf
s_waitcnt lgkmcnt(11)
s_nop 0
v_mfma_f32_16x16x32_bf16 v[20:23], v[80:83], v[12:15], v[20:23]
v_and_b32_dpp v16, v53, v8 row_newbcast:5 row_mask:0xf bank_mask:0xf
v_and_b32_dpp v17, v53, v9 row_newbcast:5 row_mask:0xf bank_mask:0xf
v_and_b32_dpp v18, v53, v10 row_newbcast:5 row_mask:0xf bank_mask:0xf
v_and_b32_dpp v19, v53, v11 row_newbcast:5 row_mask:0xf bank_mask:0xf
s_waitcnt lgkmcnt(10)
s_nop 0
v_mfma_f32_16x16x32_bf16 v[20:23], v[84:87], v[16:19], v[20:23]
v_and_b32_dpp v12, v53, v8 row_newbcast:6 row_mask:0xf bank_mask:0xf
v_and_b32_dpp v13, v53, v9 row_newbcast:6 row_mask:0xf bank_mask:0xf
v_and_b32_dpp v14, v53, v10 row_newbcast:6 row_mask:0xf bank_mask:0xf
v_and_b32_dpp v15, v53, v11 row_newbcast:6 row_mask:0xf bank_mask:0xf
s_waitcnt lgkmcnt(9)
s_nop 0
v_mfma_f32_16x16x32_bf16 v[20:23], v[88:91], v[12:15], v[20:23]
v_and_b32_dpp v16, v53, v8 row_newbcast:7 row_mask:0xf bank_mask:0xf
v_and_b32_dpp v17, v53, v9 row_newbcast:7 row_mask:0xf bank_mask:0xf
v_and_b32_dpp v18, v53, v10 row_newbcast:7 row_mask:0xf bank_mask:0xf
v_and_b32_dpp v19, v53, v11 row_newbcast:7 row_mask:0xf bank_mask:0xf
s_waitcnt lgkmcnt(8)
s_nop 0
v_mfma_f32_16x16x32_bf16 v[20:23], v[92:95], v[16:19], v[20:23]
v_and_b32_dpp v12, v53, v8 row_newbcast:8 row_mask:0xf bank_mask:0xf
v_and_b32_dpp v13, v53, v9 row_newbcast:8 row_mask:0xf bank_mask:0xf
v_and_b32_dpp v14, v53, v10 row_newbcast:8 row_mask:0xf bank_mask:0xf
v_and_b32_dpp v15, v53, v11 row_newbcast:8 row_mask:0xf bank_mask:0xf
s_waitcnt lgkmcnt(7)
s_nop 0
v_mfma_f32_16x16x32_bf16 v[20:23], v[96:99], v[12:15], v[20:23]
v_and_b32_dpp v16, v53, v8 row_newbcast:9 row_mask:0xf bank_mask:0xf
v_and_b32_dpp v17, v53, v9 row_newbcast:9 row_mask:0xf bank_mask:0xf
v_and_b32_dpp v18, v53, v10 row_newbcast:9 row_mask:0xf bank_mask:0xf
v_and_b32_dpp v19, v53, v11 row_newbcast:9 row_mask:0xf bank_mask:0xf
s_waitcnt lgkmcnt(6)
s_nop 0
v_mfma_f32_16x16x32_bf16 v[20:23], v[100:103], v[16:19], v[20:23]
v_and_b32_dpp v12, v53, v8 row_newbcast:10 row_mask:0xf bank_mask:0xf
v_and_b32_dpp v13, v53, v9 row_newbcast:10 row_mask:0xf bank_mask:0xf
v_and_b32_dpp v14, v53, v10 row_newbcast:10 row_mask:0xf bank_mask:0xf
v_and_b32_dpp v15, v53, v11 row_newbcast:10 row_mask:0xf bank_mask:0xf
s_waitcnt lgkmcnt(5)
s_nop 0
v_mfma_f32_16x16x32_bf16 v[20:23], v[104:107], v[12:15], v[20:23]
v_and_b32_dpp v16, v53, v8 row_newbcast:11 row_mask:0xf bank_mask:0xf
v_and_b32_dpp v17, v53, v9 row_newbcast:11 row_mask:0xf bank_mask:0xf
v_and_b32_dpp v18, v53, v10 row_newbcast:11 row_mask:0xf bank_mask:0xf
v_and_b32_dpp v19, v53, v11 row_newbcast:11 row_mask:0xf bank_mask:0xf
s_waitcnt lgkmcnt(4)
s_nop 0
v_mfma_f32_16x16x32_bf16 v[20:23], v[108:111], v[16:19], v[20:23]
v_and_b32_dpp v12, v53, v8 row_newbcast:12 row_mask:0xf bank_mask:0xf
v_and_b32_dpp v13, v53, v9 row_newbcast:12 row_mask:0xf bank_mask:0xf
v_and_b32_dpp v14, v53, v10 row_newbcast:12 row_mask:0xf bank_mask:0xf
v_and_b32_dpp v15, v53, v11 row_newbcast:12 row_mask:0xf bank_mask:0xf
s_waitcnt lgkmcnt(3)
s_nop 0
v_mfma_f32_16x16x32_bf16 v[20:23], v[112:115], v[12:15], v[20:23]
v_and_b32_dpp v16, v53, v8 row_newbcast:13 row_mask:0xf bank_mask:0xf
v_and_b32_dpp v17, v53, v9 row_newbcast:13 row_mask:0xf bank_mask:0xf
v_and_b32_dpp v18, v53, v10 row_newbcast:13 row_mask:0xf bank_mask:0xf
v_and_b32_dpp v19, v53, v11 row_newbcast:13 row_mask:0xf bank_mask:0xf
s_waitcnt lgkmcnt(2)
s_nop 0
v_mfma_f32_16x16x32_bf16 v[20:23], v[116:119], v[16:19], v[20:23]
v_and_b32_dpp v12, v53, v8 row_newbcast:14 row_mask:0xf bank_mask:0xf
v_and_b32_dpp v13, v53, v9 row_newbcast:14 row_mask:0xf bank_mask:0xf
v_and_b32_dpp v14, v53, v10 row_newbcast:14 row_mask:0xf bank_mask:0xf
v_and_b32_dpp v15, v53, v11 row_newbcast:14 row_mask:0xf bank_mask:0xf
s_waitcnt lgkmcnt(1)
s_nop 0
v_mfma_f32_16x16x32_bf16 v[20:23], v[120:123], v[12:15], v[20:23]
v_and_b32_dpp v16, v53, v8 row_newbcast:15 row_mask:0xf bank_mask:0xf
v_and_b32_dpp v17, v53, v9 row_newbcast:15 row_mask:0xf bank_mask:0xf
v_and_b32_dpp v18, v53, v10 row_newbcast:15 row_mask:0xf bank_mask:0xf
v_and_b32_dpp v19, v53, v11 row_newbcast:15 row_mask:0xf bank_mask:0xf
s_waitcnt lgkmcnt(0)
s_nop 0
v_mfma_f32_16x16x32_bf16 v[20:23], v[124:127], v[16:19], v[20:23]
s_lshl_b32 s61, s49, 2
s_add_u32 s61, s61, s50
s_lshl_b32 s61, s61, 3
s_lshl_b32 s42, s3, 1
s_add_u32 s61, s61, s42
s_lshl_b32 s61, s61, 10
s_add_u32 s61, s61, 1572864
s_mov_b32 exec_lo, 0x00ff00ff
s_mov_b32 exec_hi, 0x00ff00ff
v_mov_b32 v40, v20
v_mov_b32 v41, v21
v_mov_b32 v44, v22
v_mov_b32 v45, v23
buffer_store_dwordx4 v[40:43], v52, s[12:15], s40 offen sc1
buffer_store_dwordx4 v[44:47], v52, s[12:15], s40 offen offset:128 sc1
s_mov_b64 exec, -1
s_mov_b32 s16, s26
s_mov_b32 s17, s27
s_mov_b32 s18, 0x400000
s_mov_b32 s19, 0x20000
s_cmp_eq_u32 s48, 1
s_cselect_b32 s18, s18, 0
v_lshlrev_b32 v27, 10, v2
v_lshl_add_u32 v27, v3, 4, v27
s_lshl_b32 s40, s49, 17
s_lshl_b32 s41, s50, 8
s_add_u32 s40, s40, s41
s_lshl_b32 s41, s3, 15
s_add_u32 s40, s40, s41
buffer_load_dwordx4 v[128:131], v27, s[16:19], s40 offen nt
s_add_u32 s40, s40, 4096
buffer_load_dwordx4 v[132:135], v27, s[16:19], s40 offen nt
s_add_u32 s40, s40, 4096
buffer_load_dwordx4 v[136:139], v27, s[16:19], s40 offen nt
s_add_u32 s40, s40, 4096
buffer_load_dwordx4 v[140:143], v27, s[16:19], s40 offen nt
s_add_u32 s40, s40, 4096
buffer_load_dwordx4 v[144:147], v27, s[16:19], s40 offen nt
s_add_u32 s40, s40, 4096
buffer_load_dwordx4 v[148:151], v27, s[16:19], s40 offen nt
s_add_u32 s40, s40, 4096
buffer_load_dwordx4 v[152:155], v27, s[16:19], s40 offen nt
s_add_u32 s40, s40, 4096
buffer_load_dwordx4 v[156:159], v27, s[16:19], s40 offen nt
s_add_u32 s40, s40, 4096
v_mov_b32 v28, -1
v_mov_b32 v29, -1
v_mov_b32 v30, -1
v_mov_b32 v31, -1
v_and_b32 v27, 255, v0
s_lshl_b32 s40, s51, 2
s_add_u32 s40, s40, s48
s_lshl_b32 s54, s40, 10
s_add_u32 s54, s54, 0
s_xor_b32 s85, s54, 0x1800
v_lshlrev_b32 v32, 2, v27
buffer_store_dword v28, v32, s[12:15], s54 offen sc1
buffer_store_dword v28, v32, s[12:15], s85 offen sc1
v_lshlrev_b32 v33, 16, v2
v_bfe_u32 v34, v0, 3, 1
v_lshl_add_u32 v33, v34, 10, v33
v_and_b32 v34, 7, v0
v_lshl_add_u32 v33, v34, 2, v33
s_lshl_b32 s60, s50, 14
s_lshl_b32 s40, s3, 12
s_add_u32 s60, s60, s40
s_lshl_b32 s40, s49, 5
s_add_u32 s60, s60, s40
s_add_u32 s60, s60, 524288
s_cmp_eq_u32 s48, 1
s_cselect_b32 s60, s60, 0x40000000
buffer_store_dword v28, v33, s[12:15], s60 offen sc1
buffer_store_dword v28, v33, s[12:15], s60 offen offset:2048 sc1
s_lshr_b32 s79, s2, 3
s_sub_u32 s79, s79, 16
s_lshl_b32 s79, s79, 2
s_add_u32 s79, s79, s77
s_lshl_b32 s79, s79, 2
s_add_u32 s79, s79, s3
s_cmp_eq_u32 s48, 1
s_cselect_b32 s79, s79, 0x10000
v_bfe_u32 v36, v0, 2, 1
v_bfe_u32 v37, v0, 3, 1
v_lshl_add_u32 v36, v37, 1, v36
v_bfe_u32 v37, v0, 5, 1
v_lshl_add_u32 v36, v37, 2, v36
v_and_b32 v37, 3, v0
v_bfe_u32 v38, v0, 4, 1
v_lshl_add_u32 v37, v38, 2, v37
v_lshlrev_b32 v37, 13, v37
v_lshl_add_u32 v37, v36, 2, v37
s_lshl_b32 s55, s79, 5
s_add_u32 s55, s55, 1048576
s_cmp_lt_u32 s79, 256
s_cselect_b32 s55, s55, 0x40000000
buffer_store_dword v28, v37, s[12:15], s55 offen sc1
s_lshl_b32 s59, s2, 13
s_add_u32 s59, s59, 1114112
s_cmp_lt_u32 s2, 56
s_cselect_b32 s59, s59, 0x40000000
s_add_u32 s40, s59, 4096
v_lshlrev_b32 v27, 4, v27
buffer_store_dwordx4 v[28:31], v27, s[12:15], s59 offen sc1
buffer_store_dwordx4 v[28:31], v27, s[12:15], s40 offen sc1
s_mov_b32 s16, s20
s_mov_b32 s17, s21
s_mov_b32 s18, 0x1000
s_mov_b32 s19, 0x20000
v_lshlrev_b32 v38, 1, v36
s_lshl_b32 s40, s79, 4
buffer_load_ushort v39, v38, s[16:19], s40 offen
v_and_b32 v52, 7, v0
v_and_b32 v53, 63, v0
v_lshlrev_b32 v53, 1, v53
v_sub_u32 v52, v53, v52
v_lshlrev_b32 v52, 2, v52
s_lshl_b32 s40, s3, 9
v_add_u32 v52, s40, v52
s_mov_b32 s66, 0
L_pq:
buffer_load_dwordx4 v[64:67], v1, s[12:15], s61 offen sc1
buffer_load_dwordx4 v[68:71], v1, s[12:15], s61 offen offset:1024 sc1
s_waitcnt vmcnt(0)
v_xor_b32 v72, s56, v66
v_xor_b32 v73, s57, v67
v_xor_b32 v74, s56, v70
v_xor_b32 v75, s57, v71
v_or3_b32 v72, v72, v73, v74
v_or_b32 v72, v72, v75
v_cmp_ne_u32 vcc, 0, v72
s_cbranch_vccz L_pq_ok
s_mov_b64 exec, vcc
s_add_u32 s66, s66, 1
s_cmp_gt_u32 s66, 400000
s_cbranch_scc1 L_pq_ok
s_sleep 4
s_branch L_pq
L_pq_ok:
s_mov_b64 exec, -1
v_add_f32 v64, v64, v68
v_add_f32 v65, v65, v69
ds_write_b32 v52, v64 offset:8192
ds_write_b32 v52, v65 offset:8224
s_waitcnt lgkmcnt(0)
s_barrier
v_lshlrev_b32 v39, 16, v39
v_mov_b32 v28, 14368
v_mov_b32 v29, 1
s_mov_b64 exec, 1
ds_add_rtn_u32 v29, v28, v29 offset:4
s_waitcnt lgkmcnt(0)
s_mov_b64 exec, -1
v_readfirstlane_b32 s70, v29
s_cmp_eq_u32 s48, 0
s_cbranch_scc1 L_nowo
s_lshl_b32 s41, s3, 13
s_add_u32 s41, s41, 60608
v_add_u32 v24, s41, v1
v_bfe_u32 v25, v0, 2, 2
v_lshlrev_b32 v25, 8, v25
v_lshl_add_u32 v25, v2, 11, v25
v_and_b32 v28, 3, v0
v_lshl_add_u32 v25, v28, 3, v25
s_lshl_b32 s41, s3, 6
s_add_u32 s41, s41, 60608
v_add_u32 v25, s41, v25
ds_write_b128 v24, v[128:131] offset:0
ds_write_b128 v24, v[132:135] offset:1024
ds_write_b128 v24, v[136:139] offset:2048
ds_write_b128 v24, v[140:143] offset:3072
ds_write_b128 v24, v[144:147] offset:4096
ds_write_b128 v24, v[148:151] offset:5120
ds_write_b128 v24, v[152:155] offset:6144
ds_write_b128 v24, v[156:159] offset:7168
v_mov_b32 v28, 14368
v_mov_b32 v29, 1
s_mov_b64 exec, 1
s_waitcnt lgkmcnt(0)
ds_add_u32 v28, v29 offset:12
L_gs_2:
ds_read_b32 v29, v28 offset:12
s_waitcnt lgkmcnt(0)
v_readfirstlane_b32 s43, v29
s_cmp_lt_u32 s43, 8
s_cbranch_scc1 L_gs_2
s_mov_b64 exec, -1
ds_read_b64_tr_b16 v[160:161], v25 offset:0
ds_read_b64_tr_b16 v[162:163], v25 offset:1024
ds_read_b64_tr_b16 v[164:165], v25 offset:8192
ds_read_b64_tr_b16 v[166:167], v25 offset:9216
ds_read_b64_tr_b16 v[168:169], v25 offset:16384
ds_read_b64_tr_b16 v[170:171], v25 offset:17408
ds_read_b64_tr_b16 v[172:173], v25 offset:24576
ds_read_b64_tr_b16 v[174:175], v25 offset:25600
ds_read_b64_tr_b16 v[176:177], v25 offset:32
ds_read_b64_tr_b16 v[178:179], v25 offset:1056
ds_read_b64_tr_b16 v[180:181], v25 offset:8224
ds_read_b64_tr_b16 v[182:183], v25 offset:9248
ds_read_b64_tr_b16 v[184:185], v25 offset:16416
ds_read_b64_tr_b16 v[186:187], v25 offset:17440
ds_read_b64_tr_b16 v[188:189], v25 offset:24608
ds_read_b64_tr_b16 v[190:191], v25 offset:25632
L_nowo:
s_lshr_b32 s40, s2, 4
s_lshl_b32 s40, s40, 2
s_add_u32 s40, s40, s77
s_lshl_b32 s40, s40, 1
s_bfe_u32 s78, s2, 0x10003
s_add_u32 s78, s78, s40
s_cmp_eq_u32 s48, 0
s_cselect_b32 s78, s78, 255
s_cmp_ge_u32 s78, 56
s_cbranch_scc1 L_notouch
s_cmp_lt_u32 s3, 2
s_cselect_b32 s42, s28, s30
s_cselect_b32 s43, s29, s31
s_mov_b32 s16, s42
s_mov_b32 s17, s43
s_mov_b32 s18, 0x1c0000
s_mov_b32 s19, 0x20000
v_and_b32 v28, 1, v0
v_mul_u32_u24 v28, 913920, v28
s_lshl_b32 s40, s78, 6
s_and_b32 s41, s3, 1
s_mul_i32 s41, s41, 917504
s_add_u32 s40, s40, s41
s_mov_b64 exec, 3
buffer_load_dword v61, v28, s[16:19], s40 offen nt
s_mov_b32 s16, s32
s_mov_b32 s17, s33
s_mov_b32 s18, 0x1c0000
s_mov_b32 s19, 0x20000
v_mov_b32 v28, 0
s_lshl_b32 s40, s78, 15
buffer_load_dword v61, v28, s[16:19], s40 offen nt
s_mov_b64 exec, -1
L_notouch:
s_cmp_lg_u32 s70, 3
s_cbranch_scc1 L_noinit
s_bfe_u32 s41, s2, 0x20003
s_add_u32 s41, s41, 1
v_mov_b32 v28, 14368
L_iw:
ds_read_b32 v29, v28
s_waitcnt lgkmcnt(0)
v_readfirstlane_b32 s40, v29
s_cmp_ge_u32 s40, s41
s_cbranch_scc1 L_iw_ok
s_sleep 32
s_branch L_iw
L_iw_ok:
s_mov_b32 s64, 1
s_atomic_add s64, s[44:45], 0
L_noinit:
v_lshlrev_b32 v34, 10, v2
v_lshl_add_u32 v35, v3, 5, v34
s_lshl_b32 s40, s49, 12
s_lshl_b32 s41, s3, 17
s_add_u32 s88, s40, s41
s_add_u32 s88, s88, 0
v_lshlrev_b32 v4, 4, v3
v_lshl_add_u32 v4, v2, 2, v4
v_bfe_u32 v5, v0, 4, 1
v_bfe_u32 v6, v0, 5, 1
v_lshlrev_b32 v4, 4, v3
v_lshl_add_u32 v4, v6, 3, v4
v_lshl_add_u32 v4, v5, 2, v4
s_mul_i32 s40, s3, 272
v_add_u32 v4, s40, v4
v_bfe_u32 v5, v0, 2, 2
v_mul_u32_u24 v5, 272, v5
v_lshl_add_u32 v5, v2, 4, v5
s_lshl_b32 s40, s3, 5
v_lshlrev_b32 v6, 2, v36
v_add_u32 v6, s40, v6
v_and_b32 v7, 7, v0
v_lshlrev_b32 v7, 4, v7
v_bfe_u32 v37, v0, 3, 3
v_lshl_add_u32 v37, v37, 13, v7
s_lshl_b32 s62, s79, 10
s_add_u32 s62, s62, 524288
v_and_b32 v44, 31, v0
v_lshlrev_b32 v44, 5, v44
v_bfe_u32 v45, v0, 5, 1
v_lshl_add_u32 v44, v45, 4, v44
v_lshlrev_b32 v45, 9, v1
s_lshl_b32 s63, s79, 5
s_add_u32 s63, s63, 1114112
s_lshl_b32 s67, s79, 4
s_cmp_lg_u32 s3, 1
s_cbranch_scc1 L_nokd
v_mov_b32 v28, 14368
L_kw:
ds_read_b32 v29, v28 offset:20
s_waitcnt lgkmcnt(0)
v_readfirstlane_b32 s40, v29
s_cmp_ge_u32 s40, 4
s_cbranch_scc1 L_kw1
s_sleep 16
s_branch L_kw
L_kw1:
v_mov_b32 v28, 19584
ds_read_b128 v[48:51], v28 offset:16
ds_read_b32 v52, v28 offset:4
s_lshl_b32 s40, s51, 1
s_add_u32 s40, s40, s48
s_lshl_b32 s40, s40, 6
s_add_u32 s40, s40, 2752512
v_mov_b32 v29, 0
s_waitcnt lgkmcnt(0)
v_max_f32 v48, v48, v49
v_max3_f32 v48, v48, v50, v51
v_mov_b32 v49, v52
v_mov_b32 v50, s56
v_mov_b32 v51, s57
s_mov_b64 exec, 1
buffer_store_dwordx4 v[48:51], v29, s[12:15], s40 offen sc1
s_xor_b32 s40, s40, 64
s_mov_b32 s66, 0
L_kp:
buffer_load_dwordx4 v[52:55], v29, s[12:15], s40 offen sc1
s_waitcnt vmcnt(0)
v_xor_b32 v54, s56, v54
v_xor_b32 v55, s57, v55
v_or_b32 v54, v54, v55
v_cmp_ne_u32 vcc, 0, v54
s_cbranch_vccz L_kp1
s_add_u32 s66, s66, 1
s_cmp_gt_u32 s66, 400000
s_cbranch_scc1 L_kp1
s_sleep 8
s_branch L_kp
L_kp1:
v_mov_b32 v53, v52
v_mov_b32 v52, 1
ds_write_b64 v28, v[52:53] offset:8
s_mov_b64 exec, -1
L_nokd:
s_cmp_lg_u32 s3, 2
s_cbranch_scc1 L_nosk
v_mov_b32 v28, 14368
L_sw:
ds_read_b32 v29, v28
s_waitcnt lgkmcnt(0)
v_readfirstlane_b32 s40, v29
s_cmp_ge_u32 s40, 16
s_cbranch_scc1 L_sw_ok
s_sleep 32
s_branch L_sw
L_sw_ok:
s_add_u32 s82, s82, 1
s_addc_u32 s83, s83, 0
s_xor_b32 s40, s51, 1
s_lshl_b32 s41, s40, 7
s_add_u32 s41, s41, 2752512
v_mov_b32 v29, 0
v_mov_b32 v28, 19584
s_mov_b64 exec, 1
s_mov_b32 s66, 0
L_sp:
buffer_load_dwordx4 v[48:51], v29, s[12:15], s41 offen sc1
buffer_load_dwordx4 v[52:55], v29, s[12:15], s41 offen offset:64 sc1
s_waitcnt vmcnt(0)
v_xor_b32 v50, s82, v50
v_xor_b32 v51, s83, v51
v_xor_b32 v54, s82, v54
v_xor_b32 v55, s83, v55
v_or3_b32 v50, v50, v51, v54
v_or_b32 v50, v50, v55
v_cmp_ne_u32 vcc, 0, v50
s_cbranch_vccz L_sp1
s_add_u32 s66, s66, 1
s_cmp_gt_u32 s66, 64
s_cbranch_scc1 L_sp2
s_sleep 32
s_branch L_sp
L_sp1:
v_max_f32 v50, v48, v52
v_mov_b32 v48, 1
ds_write_b32 v28, v50 offset:36
ds_write_b32 v28, v49 offset:40
s_waitcnt lgkmcnt(0)
ds_write_b32 v28, v48 offset:32
L_sp2:
s_mov_b64 exec, -1
L_nosk:
v_mov_b32 v28, 14368
L_w2:
ds_read_b32 v29, v28
s_waitcnt lgkmcnt(0)
v_readfirstlane_b32 s40, v29
s_cmp_ge_u32 s40, 15
s_cbranch_scc1 L_w2_ok
s_sleep 32
s_branch L_w2
L_w2_ok:
v_lshrrev_b32 v28, 1, v1
v_mov_b32 v29, 0
s_mov_b32 s16, s44
s_mov_b32 s17, s45
s_mov_b32 s18, 0x100
s_mov_b32 s19, 0x20000
s_mov_b32 s66, 0
L_initchk:
buffer_load_dword v31, v29, s[16:19], 0 offen sc1
s_waitcnt vmcnt(0)
v_readfirstlane_b32 s64, v31
s_cmp_ge_u32 s64, 256
s_cbranch_scc1 L_initok
s_add_u32 s66, s66, 1
s_cmp_gt_u32 s66, 200000
s_cbranch_scc1 L_initok
s_sleep 8
s_branch L_initchk
L_initok:
s_setprio 0
v_mov_b32 v27, 14368
L_wf:
ds_read_b32 v30, v27 offset:16
s_waitcnt lgkmcnt(0)
v_readfirstlane_b32 s40, v30
s_cmp_ge_u32 s40, 4
s_cbranch_scc1 L_wf_ok
s_sleep 1
s_branch L_wf
L_wf_ok:
s_setprio 3
v_lshrrev_b32 v28, 1, v1
s_cmp_eq_u32 s3, 0
s_cselect_b32 s54, s54, s85
s_mov_b32 s40, 21632
s_cselect_b32 s40, 10240, s40
v_add_u32 v30, s40, v28
s_mov_b32 s40, 25728
s_cselect_b32 s40, 14336, s40
v_mov_b32 v29, s40
s_mov_b32 s16, s34
s_mov_b32 s17, s35
s_mov_b32 s18, 0x1000
s_mov_b32 s19, 0x20000
s_cmp_ge_u32 s3, 2
s_cbranch_scc1 L_st2
ds_read_b128 v[48:51], v29
ds_read_b128 v[52:55], v29 offset:16
ds_read_b64 v[96:97], v30 offset:0
ds_read_b64 v[98:99], v30 offset:1024
ds_read_b64 v[100:101], v30 offset:2048
ds_read_b64 v[102:103], v30 offset:3072
s_waitcnt lgkmcnt(4)
v_max_f32 v56, v48, v50
v_max3_f32 v56, v56, v52, v54
v_sub_f32 v58, v48, v56
v_sub_f32 v59, v50, v56
v_sub_f32 v60, v52, v56
v_sub_f32 v61, v54, v56
v_mul_f32 v58, 0x3fb8aa3b, v58
v_mul_f32 v59, 0x3fb8aa3b, v59
v_mul_f32 v60, 0x3fb8aa3b, v60
v_mul_f32 v61, 0x3fb8aa3b, v61
v_exp_f32 v58, v58
v_exp_f32 v59, v59
v_exp_f32 v60, v60
v_exp_f32 v61, v61
s_waitcnt lgkmcnt(0)
v_mul_f32 v57, v58, v49
v_mul_f32 v96, v96, v58
v_mul_f32 v97, v97, v58
v_fmac_f32 v57, v59, v51
v_fmac_f32 v96, v98, v59
v_fmac_f32 v97, v99, v59
v_fmac_f32 v57, v60, v53
v_fmac_f32 v96, v100, v60
v_fmac_f32 v97, v101, v60
v_fmac_f32 v57, v61, v55
v_fmac_f32 v96, v102, v61
v_fmac_f32 v97, v103, v61
v_min_u32 v96, -2, v96
v_min_u32 v97, -2, v97
v_min_u32 v56, -2, v56
v_min_u32 v57, -2, v57
buffer_store_dwordx2 v[96:97], v28, s[12:15], s54 offen sc1
s_mov_b64 exec, 1
buffer_store_dwordx2 v[56:57], v28, s[12:15], s54 offen offset:512 sc1
s_mov_b64 exec, -1
L_st2:
s_cmp_eq_u32 s48, 1
s_cbranch_scc1 L_st2b
s_cmp_ge_u32 s78, 56
s_cbranch_scc1 L_fin
s_cmp_lt_u32 s3, 2
s_cselect_b32 s42, s28, s30
s_cselect_b32 s43, s29, s31
s_mov_b32 s16, s42
s_mov_b32 s17, s43
s_mov_b32 s18, 0x1c0000
s_mov_b32 s19, 0x20000
v_bfe_u32 v26, v0, 2, 4
v_mul_u32_u24 v26, 3584, v26
v_and_b32 v28, 3, v0
v_lshl_add_u32 v26, v28, 4, v26
s_lshl_b32 s40, s78, 6
s_and_b32 s41, s3, 1
s_mul_i32 s41, s41, 917504
s_add_u32 s40, s40, s41
buffer_load_dwordx4 v[128:131], v26, s[16:19], s40 offen
s_add_u32 s40, s40, 57344
buffer_load_dwordx4 v[132:135], v26, s[16:19], s40 offen
s_add_u32 s40, s40, 57344
buffer_load_dwordx4 v[136:139], v26, s[16:19], s40 offen
s_add_u32 s40, s40, 57344
buffer_load_dwordx4 v[140:143], v26, s[16:19], s40 offen
s_add_u32 s40, s40, 57344
buffer_load_dwordx4 v[144:147], v26, s[16:19], s40 offen
s_add_u32 s40, s40, 57344
buffer_load_dwordx4 v[148:151], v26, s[16:19], s40 offen
s_add_u32 s40, s40, 57344
buffer_load_dwordx4 v[152:155], v26, s[16:19], s40 offen
s_add_u32 s40, s40, 57344
buffer_load_dwordx4 v[156:159], v26, s[16:19], s40 offen
s_add_u32 s40, s40, 57344
buffer_load_dwordx4 v[160:163], v26, s[16:19], s40 offen
s_add_u32 s40, s40, 57344
buffer_load_dwordx4 v[164:167], v26, s[16:19], s40 offen
s_add_u32 s40, s40, 57344
buffer_load_dwordx4 v[168:171], v26, s[16:19], s40 offen
s_add_u32 s40, s40, 57344
buffer_load_dwordx4 v[172:175], v26, s[16:19], s40 offen
s_add_u32 s40, s40, 57344
buffer_load_dwordx4 v[176:179], v26, s[16:19], s40 offen
s_add_u32 s40, s40, 57344
buffer_load_dwordx4 v[180:183], v26, s[16:19], s40 offen
s_add_u32 s40, s40, 57344
buffer_load_dwordx4 v[184:187], v26, s[16:19], s40 offen
s_add_u32 s40, s40, 57344
buffer_load_dwordx4 v[188:191], v26, s[16:19], s40 offen
s_add_u32 s40, s40, 57344
s_mov_b32 s16, s32
s_mov_b32 s17, s33
s_mov_b32 s18, 0x1c0000
s_mov_b32 s19, 0x20000
v_lshlrev_b32 v26, 13, v2
v_lshl_add_u32 v26, v3, 3, v26
s_lshl_b32 s40, s78, 15
s_lshl_b32 s41, s3, 8
s_add_u32 s40, s40, s41
buffer_load_dwordx2 v[64:65], v26, s[16:19], s40 offen offset:0 nt
buffer_load_dwordx2 v[66:67], v26, s[16:19], s40 offen offset:128 nt
buffer_load_dwordx2 v[68:69], v26, s[16:19], s40 offen offset:1024 nt
buffer_load_dwordx2 v[70:71], v26, s[16:19], s40 offen offset:1152 nt
buffer_load_dwordx2 v[72:73], v26, s[16:19], s40 offen offset:2048 nt
buffer_load_dwordx2 v[74:75], v26, s[16:19], s40 offen offset:2176 nt
buffer_load_dwordx2 v[76:77], v26, s[16:19], s40 offen offset:3072 nt
buffer_load_dwordx2 v[78:79], v26, s[16:19], s40 offen offset:3200 nt
s_add_u32 s40, s40, 4096
buffer_load_dwordx2 v[80:81], v26, s[16:19], s40 offen offset:0 nt
buffer_load_dwordx2 v[82:83], v26, s[16:19], s40 offen offset:128 nt
buffer_load_dwordx2 v[84:85], v26, s[16:19], s40 offen offset:1024 nt
buffer_load_dwordx2 v[86:87], v26, s[16:19], s40 offen offset:1152 nt
buffer_load_dwordx2 v[88:89], v26, s[16:19], s40 offen offset:2048 nt
buffer_load_dwordx2 v[90:91], v26, s[16:19], s40 offen offset:2176 nt
buffer_load_dwordx2 v[92:93], v26, s[16:19], s40 offen offset:3072 nt
buffer_load_dwordx2 v[94:95], v26, s[16:19], s40 offen offset:3200 nt
s_mov_b32 s80, 0x05040100
s_mov_b32 s81, 0x07060302
s_lshl_b32 s41, s3, 14
s_add_u32 s41, s41, 60608
v_add_u32 v24, s41, v1
v_bfe_u32 v25, v0, 2, 2
v_lshlrev_b32 v25, 6, v25
v_lshl_add_u32 v25, v2, 9, v25
v_and_b32 v28, 3, v0
v_lshl_add_u32 v25, v28, 3, v25
s_lshr_b32 s41, s3, 1
s_lshl_b32 s41, s41, 15
s_and_b32 s42, s3, 1
s_lshl_b32 s42, s42, 5
s_add_u32 s41, s41, s42
s_add_u32 s41, s41, 60608
v_add_u32 v25, s41, v25
s_waitcnt vmcnt(31)
ds_write_b128 v24, v[128:131] offset:0
s_waitcnt vmcnt(30)
ds_write_b128 v24, v[132:135] offset:1024
s_waitcnt vmcnt(29)
ds_write_b128 v24, v[136:139] offset:2048
s_waitcnt vmcnt(28)
ds_write_b128 v24, v[140:143] offset:3072
s_waitcnt vmcnt(27)
ds_write_b128 v24, v[144:147] offset:4096
s_waitcnt vmcnt(26)
ds_write_b128 v24, v[148:151] offset:5120
s_waitcnt vmcnt(25)
ds_write_b128 v24, v[152:155] offset:6144
s_waitcnt vmcnt(24)
ds_write_b128 v24, v[156:159] offset:7168
s_waitcnt vmcnt(23)
ds_write_b128 v24, v[160:163] offset:8192
s_waitcnt vmcnt(22)
ds_write_b128 v24, v[164:167] offset:9216
s_waitcnt vmcnt(21)
ds_write_b128 v24, v[168:171] offset:10240
s_waitcnt vmcnt(20)
ds_write_b128 v24, v[172:175] offset:11264
s_waitcnt vmcnt(19)
ds_write_b128 v24, v[176:179] offset:12288
s_waitcnt vmcnt(18)
ds_write_b128 v24, v[180:183] offset:13312
s_waitcnt vmcnt(17)
ds_write_b128 v24, v[184:187] offset:14336
s_waitcnt vmcnt(16)
ds_write_b128 v24, v[188:191] offset:15360
s_waitcnt lgkmcnt(0)
s_barrier
ds_read_b64_tr_b16 v[128:129], v25 offset:0
ds_read_b64_tr_b16 v[130:131], v25 offset:256
ds_read_b64_tr_b16 v[132:133], v25 offset:2048
ds_read_b64_tr_b16 v[134:135], v25 offset:2304
ds_read_b64_tr_b16 v[136:137], v25 offset:4096
ds_read_b64_tr_b16 v[138:139], v25 offset:4352
ds_read_b64_tr_b16 v[140:141], v25 offset:6144
ds_read_b64_tr_b16 v[142:143], v25 offset:6400
ds_read_b64_tr_b16 v[144:145], v25 offset:8192
ds_read_b64_tr_b16 v[146:147], v25 offset:8448
ds_read_b64_tr_b16 v[148:149], v25 offset:10240
ds_read_b64_tr_b16 v[150:151], v25 offset:10496
ds_read_b64_tr_b16 v[152:153], v25 offset:12288
ds_read_b64_tr_b16 v[154:155], v25 offset:12544
ds_read_b64_tr_b16 v[156:157], v25 offset:14336
ds_read_b64_tr_b16 v[158:159], v25 offset:14592
ds_read_b64_tr_b16 v[160:161], v25 offset:16384
ds_read_b64_tr_b16 v[162:163], v25 offset:16640
ds_read_b64_tr_b16 v[164:165], v25 offset:18432
ds_read_b64_tr_b16 v[166:167], v25 offset:18688
ds_read_b64_tr_b16 v[168:169], v25 offset:20480
ds_read_b64_tr_b16 v[170:171], v25 offset:20736
ds_read_b64_tr_b16 v[172:173], v25 offset:22528
ds_read_b64_tr_b16 v[174:175], v25 offset:22784
ds_read_b64_tr_b16 v[176:177], v25 offset:24576
ds_read_b64_tr_b16 v[178:179], v25 offset:24832
ds_read_b64_tr_b16 v[180:181], v25 offset:26624
ds_read_b64_tr_b16 v[182:183], v25 offset:26880
ds_read_b64_tr_b16 v[184:185], v25 offset:28672
ds_read_b64_tr_b16 v[186:187], v25 offset:28928
ds_read_b64_tr_b16 v[188:189], v25 offset:30720
ds_read_b64_tr_b16 v[190:191], v25 offset:30976
s_and_b32 s40, s78, 7
s_lshl_b32 s40, s40, 13
s_lshl_b32 s41, s3, 11
s_add_u32 s73, s40, s41
s_add_u32 s73, s73, 1048576
v_lshlrev_b32 v46, 1, v1
s_mul_i32 s40, s3, 1040
v_add_u32 v47, s40, v1
v_and_b32 v43, 3, v0
v_mul_u32_u24 v43, 1040, v43
v_lshl_add_u32 v43, v2, 4, v43
v_lshlrev_b32 v40, 2, v3
s_lshr_b32 s40, s3, 1
s_lshl_b32 s40, s40, 9
s_and_b32 s41, s3, 1
s_lshl_b32 s41, s41, 6
s_add_u32 s40, s40, s41
v_add_u32 v40, s40, v40
v_bfe_u32 v41, v0, 2, 2
v_lshlrev_b32 v41, 7, v41
v_lshl_add_u32 v41, v2, 5, v41
v_and_b32 v61, 3, v0
v_lshl_add_u32 v41, v61, 3, v41
v_lshlrev_b32 v42, 11, v2
v_lshl_add_u32 v42, v3, 4, v42
s_lshl_b32 s59, s78, 13
s_lshl_b32 s40, s3, 9
s_add_u32 s59, s59, s40
s_add_u32 s59, s59, 1114112
s_waitcnt vmcnt(0)
v_perm_b32 v192, v68, v64, s80
v_perm_b32 v193, v76, v72, s80
v_perm_b32 v194, v84, v80, s80
v_perm_b32 v195, v92, v88, s80
v_perm_b32 v196, v68, v64, s81
v_perm_b32 v197, v76, v72, s81
v_perm_b32 v198, v84, v80, s81
v_perm_b32 v199, v92, v88, s81
v_perm_b32 v200, v69, v65, s80
v_perm_b32 v201, v77, v73, s80
v_perm_b32 v202, v85, v81, s80
v_perm_b32 v203, v93, v89, s80
v_perm_b32 v204, v69, v65, s81
v_perm_b32 v205, v77, v73, s81
v_perm_b32 v206, v85, v81, s81
v_perm_b32 v207, v93, v89, s81
v_perm_b32 v208, v70, v66, s80
v_perm_b32 v209, v78, v74, s80
v_perm_b32 v210, v86, v82, s80
v_perm_b32 v211, v94, v90, s80
v_perm_b32 v212, v70, v66, s81
v_perm_b32 v213, v78, v74, s81
v_perm_b32 v214, v86, v82, s81
v_perm_b32 v215, v94, v90, s81
v_perm_b32 v216, v71, v67, s80
v_perm_b32 v217, v79, v75, s80
v_perm_b32 v218, v87, v83, s80
v_perm_b32 v219, v95, v91, s80
v_perm_b32 v220, v71, v67, s81
v_perm_b32 v221, v79, v75, s81
v_perm_b32 v222, v87, v83, s81
v_perm_b32 v223, v95, v91, s81
s_branch L_glu
L_st2b:
s_mov_b32 s66, 0
L_p1:
buffer_load_dwordx4 v[64:67], v35, s[12:15], s88 offen sc1
buffer_load_dwordx4 v[68:71], v35, s[12:15], s88 offen offset:16 sc1
buffer_load_dwordx2 v[56:57], v34, s[12:15], s88 offen offset:512 sc1
s_waitcnt vmcnt(0)
v_max_u32 v31, v64, v65
v_max3_u32 v31, v31, v66, v67
v_max3_u32 v31, v31, v68, v69
v_max3_u32 v31, v31, v70, v71
v_max3_u32 v31, v31, v56, v57
v_cmp_eq_u32 vcc, -1, v31
s_cbranch_vccz L_p1_ok
s_mov_b64 exec, vcc
s_add_u32 s66, s66, 1
s_cmp_gt_u32 s66, 400000
s_cbranch_scc1 L_p1_ok
s_sleep 2
s_branch L_p1
L_p1_ok:
s_mov_b64 exec, -1
v_mov_b32 v58, v56
v_mov_b32 v59, v56
s_nop 1
v_permlane16_swap_b32 v58, v59
s_nop 0
v_max_f32 v58, v58, v59
v_mov_b32 v59, v58
s_nop 1
v_permlane32_swap_b32 v58, v59
s_nop 0
v_max_f32 v58, v58, v59
v_sub_f32 v56, v56, v58
v_mul_f32 v56, 0x3fb8aa3b, v56
v_exp_f32 v56, v56
s_nop 0
v_mul_f32 v57, v57, v56
v_mul_f32 v64, v64, v56
v_mul_f32 v65, v65, v56
v_mul_f32 v66, v66, v56
v_mul_f32 v67, v67, v56
v_mul_f32 v68, v68, v56
v_mul_f32 v69, v69, v56
v_mul_f32 v70, v70, v56
v_mul_f32 v71, v71, v56
v_mov_b32 v59, v57
s_nop 0
v_permlane32_swap_b32 v64, v68
v_permlane32_swap_b32 v65, v69
v_permlane32_swap_b32 v66, v70
v_permlane32_swap_b32 v67, v71
v_permlane16_swap_b32 v57, v59
v_add_f32 v64, v64, v68
v_add_f32 v65, v65, v69
v_add_f32 v66, v66, v70
v_add_f32 v67, v67, v71
v_add_f32 v57, v57, v59
v_mov_b32 v59, v57
v_permlane16_swap_b32 v64, v66
v_permlane16_swap_b32 v65, v67
v_permlane32_swap_b32 v57, v59
s_nop 0
v_add_f32 v57, v57, v59
v_rcp_f32 v57, v57
v_add_f32 v64, v64, v66
v_add_f32 v65, v65, v67
v_mul_f32 v64, v64, v57
v_mul_f32 v65, v65, v57
v_cvt_pk_bf16_f32 v64, v64, v65
ds_write_b32 v4, v64 offset:0
s_waitcnt lgkmcnt(0)
s_barrier
ds_read_b128 v[80:83], v5 offset:0
ds_read_b128 v[84:87], v5 offset:64
ds_read_b128 v[88:91], v5 offset:128
ds_read_b128 v[92:95], v5 offset:192
s_waitcnt lgkmcnt(3)
v_mfma_f32_16x16x32_bf16 v[20:23], v[80:83], v[160:163], 0
v_mfma_f32_16x16x32_bf16 v[24:27], v[80:83], v[176:179], 0
s_waitcnt lgkmcnt(2)
v_mfma_f32_16x16x32_bf16 v[20:23], v[84:87], v[164:167], v[20:23]
v_mfma_f32_16x16x32_bf16 v[24:27], v[84:87], v[180:183], v[24:27]
s_waitcnt lgkmcnt(1)
v_mfma_f32_16x16x32_bf16 v[20:23], v[88:91], v[168:171], v[20:23]
v_mfma_f32_16x16x32_bf16 v[24:27], v[88:91], v[184:187], v[24:27]
s_waitcnt lgkmcnt(0)
v_mfma_f32_16x16x32_bf16 v[20:23], v[92:95], v[172:175], v[20:23]
v_mfma_f32_16x16x32_bf16 v[24:27], v[92:95], v[188:191], v[24:27]
s_nop 6
v_min_u32 v20, -2, v20
buffer_store_dword v20, v33, s[12:15], s60 offen sc1
v_min_u32 v24, -2, v24
buffer_store_dword v24, v33, s[12:15], s60 offen offset:2048 sc1
s_cmp_ge_u32 s79, 256
s_cbranch_scc1 L_glu
s_mov_b32 s66, 0
L_p3:
buffer_load_dwordx4 v[48:51], v44, s[12:15], s62 offen sc1
s_waitcnt vmcnt(0)
v_max_u32 v31, v48, v49
v_max3_u32 v31, v31, v50, v51
v_cmp_eq_u32 vcc, -1, v31
s_cbranch_vccz L_p3_ok
s_mov_b64 exec, vcc
s_add_u32 s66, s66, 1
s_cmp_gt_u32 s66, 400000
s_cbranch_scc1 L_p3_ok
s_sleep 1
s_branch L_p3
L_p3_ok:
s_mov_b64 exec, -1
s_nop 3
v_add_f32_dpp v48, v48, v48 row_ror:8 row_mask:0xf bank_mask:0x3
v_add_f32_dpp v48, v50, v50 row_ror:8 row_mask:0xf bank_mask:0xc
v_add_f32_dpp v49, v49, v49 row_ror:8 row_mask:0xf bank_mask:0x3
v_add_f32_dpp v49, v51, v51 row_ror:8 row_mask:0xf bank_mask:0xc
v_add_f32_dpp v48, v48, v48 row_half_mirror row_mask:0xf bank_mask:0x5
s_nop 0
v_add_f32_dpp v48, v49, v49 row_half_mirror row_mask:0xf bank_mask:0xa
s_nop 1
v_add_f32_dpp v48, v48, v48 quad_perm:[1,0,3,2] row_mask:0xf bank_mask:0xf
s_nop 1
v_add_f32_dpp v48, v48, v48 quad_perm:[2,3,0,1] row_mask:0xf bank_mask:0xf
v_mov_b32 v49, v48
s_nop 1
v_permlane16_swap_b32 v48, v49
s_nop 1
v_add_f32 v48, v48, v49
v_cvt_pk_bf16_f32 v48, v48, v48
v_lshlrev_b32 v48, 16, v48
v_add_f32 v48, v48, v39
v_cvt_pk_bf16_f32 v48, v48, v48
v_lshlrev_b32 v48, 16, v48
v_min_u32 v39, -2, v48
ds_write_b32 v6, v39 offset:1152
s_waitcnt lgkmcnt(0)
s_barrier
s_cmp_lg_u32 s3, 0
s_cbranch_scc1 L_nohp
ds_read_b128 v[48:51], v7 offset:1152
s_waitcnt lgkmcnt(0)
buffer_store_dwordx4 v[48:51], v37, s[12:15], s55 offen sc1
L_nohp:
L_glu:
s_cmp_ge_u32 s78, 56
s_cbranch_scc1 L_s5
s_mov_b32 s66, 0
L_p4:
buffer_load_dwordx4 v[48:51], v46, s[12:15], s73 offen sc1
buffer_load_dwordx4 v[52:55], v46, s[12:15], s73 offen offset:16 sc1
s_waitcnt vmcnt(0)
v_max_u32 v31, v48, v49
v_max3_u32 v31, v31, v50, v51
v_max3_u32 v31, v31, v52, v53
v_max3_u32 v31, v31, v54, v55
v_cmp_eq_u32 vcc, -1, v31
s_cbranch_vccz L_p4_ok
s_mov_b64 exec, vcc
s_add_u32 s66, s66, 1
s_cmp_gt_u32 s66, 400000
s_cbranch_scc1 L_p4_ok
s_sleep 1
s_branch L_p4
L_p4_ok:
s_mov_b64 exec, -1
v_readfirstlane_b32 s40, v48
s_nop 1
v_subrev_f32 v56, s40, v48
v_mul_f32 v57, v56, v56
v_subrev_f32 v60, s40, v49
v_add_f32 v56, v56, v60
v_fmac_f32 v57, v60, v60
v_subrev_f32 v60, s40, v50
v_add_f32 v56, v56, v60
v_fmac_f32 v57, v60, v60
v_subrev_f32 v60, s40, v51
v_add_f32 v56, v56, v60
v_fmac_f32 v57, v60, v60
v_subrev_f32 v60, s40, v52
v_add_f32 v56, v56, v60
v_fmac_f32 v57, v60, v60
v_subrev_f32 v60, s40, v53
v_add_f32 v56, v56, v60
v_fmac_f32 v57, v60, v60
v_subrev_f32 v60, s40, v54
v_add_f32 v56, v56, v60
v_fmac_f32 v57, v60, v60
v_subrev_f32 v60, s40, v55
v_add_f32 v56, v56, v60
v_fmac_f32 v57, v60, v60
s_nop 0
v_add_f32_dpp v56, v56, v56 quad_perm:[1,0,3,2] row_mask:0xf bank_mask:0xf
v_add_f32_dpp v57, v57, v57 quad_perm:[1,0,3,2] row_mask:0xf bank_mask:0xf
s_nop 0
v_add_f32_dpp v56, v56, v56 quad_perm:[2,3,0,1] row_mask:0xf bank_mask:0xf
v_add_f32_dpp v57, v57, v57 quad_perm:[2,3,0,1] row_mask:0xf bank_mask:0xf
s_nop 0
v_add_f32_dpp v56, v56, v56 row_half_mirror row_mask:0xf bank_mask:0xf
v_add_f32_dpp v57, v57, v57 row_half_mirror row_mask:0xf bank_mask:0xf
s_nop 0
v_add_f32_dpp v56, v56, v56 row_mirror row_mask:0xf bank_mask:0xf
v_add_f32_dpp v57, v57, v57 row_mirror row_mask:0xf bank_mask:0xf
s_nop 0
v_mov_b32 v58, v56
v_mov_b32 v59, v57
s_nop 0
v_permlane16_swap_b32 v56, v58
v_permlane16_swap_b32 v57, v59
s_nop 0
v_add_f32 v56, v56, v58
v_add_f32 v57, v57, v59
v_mov_b32 v58, v56
v_mov_b32 v59, v57
s_nop 0
v_permlane32_swap_b32 v56, v58
v_permlane32_swap_b32 v57, v59
s_nop 0
v_add_f32 v56, v56, v58
v_add_f32 v57, v57, v59
v_mul_f32 v56, 0x3b000000, v56
v_mul_f32 v57, 0x3b000000, v57
v_fma_f32 v57, -v56, v56, v57
v_max_f32 v57, 0, v57
v_add_f32 v56, s40, v56
v_cvt_pk_bf16_f32 v57, v57, v57
v_lshlrev_b32 v57, 16, v57
v_cvt_pk_bf16_f32 v56, v56, v56
v_lshlrev_b32 v56, 16, v56
v_add_f32 v57, 0x3727c5ac, v57
v_cvt_pk_bf16_f32 v57, v57, v57
v_lshlrev_b32 v57, 16, v57
v_sqrt_f32 v57, v57
v_sub_f32 v48, v48, v56
v_sub_f32 v49, v49, v56
v_sub_f32 v50, v50, v56
v_sub_f32 v51, v51, v56
v_sub_f32 v52, v52, v56
v_sub_f32 v53, v53, v56
v_sub_f32 v54, v54, v56
v_sub_f32 v55, v55, v56
v_cvt_pk_bf16_f32 v57, v57, v57
v_lshlrev_b32 v57, 16, v57
v_rcp_f32 v57, v57
v_cvt_pk_bf16_f32 v48, v48, v49
v_cvt_pk_bf16_f32 v50, v50, v51
v_cvt_pk_bf16_f32 v52, v52, v53
v_cvt_pk_bf16_f32 v54, v54, v55
v_and_b32 v49, 0xffff0000, v48
v_lshlrev_b32 v48, 16, v48
v_and_b32 v51, 0xffff0000, v50
v_lshlrev_b32 v50, 16, v50
v_and_b32 v53, 0xffff0000, v52
v_lshlrev_b32 v52, 16, v52
v_and_b32 v55, 0xffff0000, v54
v_lshlrev_b32 v54, 16, v54
v_mul_f32 v48, v48, v57
v_mul_f32 v49, v49, v57
v_mul_f32 v50, v50, v57
v_mul_f32 v51, v51, v57
v_mul_f32 v52, v52, v57
v_mul_f32 v53, v53, v57
v_mul_f32 v54, v54, v57
v_mul_f32 v55, v55, v57
v_cvt_pk_bf16_f32 v48, v48, v49
v_cvt_pk_bf16_f32 v49, v50, v51
v_cvt_pk_bf16_f32 v50, v52, v53
v_cvt_pk_bf16_f32 v51, v54, v55
ds_write_b128 v47, v[48:51] offset:14400
s_mov_b64 exec, -1
s_waitcnt lgkmcnt(0)
s_barrier
ds_read_b128 v[64:67], v43 offset:14400
ds_read_b128 v[68:71], v43 offset:14464
ds_read_b128 v[72:75], v43 offset:14528
ds_read_b128 v[76:79], v43 offset:14592
ds_read_b128 v[80:83], v43 offset:14656
ds_read_b128 v[84:87], v43 offset:14720
ds_read_b128 v[88:91], v43 offset:14784
ds_read_b128 v[92:95], v43 offset:14848
ds_read_b128 v[96:99], v43 offset:14912
ds_read_b128 v[100:103], v43 offset:14976
ds_read_b128 v[104:107], v43 offset:15040
ds_read_b128 v[108:111], v43 offset:15104
ds_read_b128 v[224:227], v43 offset:15168
ds_read_b128 v[228:231], v43 offset:15232
ds_read_b128 v[232:235], v43 offset:15296
ds_read_b128 v[236:239], v43 offset:15360
s_waitcnt lgkmcnt(15)
v_mfma_f32_16x16x32_bf16 v[20:23], v[64:67], v[128:131], 0
s_waitcnt lgkmcnt(14)
v_mfma_f32_16x16x32_bf16 v[24:27], v[68:71], v[132:135], 0
s_waitcnt lgkmcnt(13)
v_mfma_f32_16x16x32_bf16 v[20:23], v[72:75], v[136:139], v[20:23]
s_waitcnt lgkmcnt(12)
v_mfma_f32_16x16x32_bf16 v[24:27], v[76:79], v[140:143], v[24:27]
s_waitcnt lgkmcnt(11)
v_mfma_f32_16x16x32_bf16 v[20:23], v[80:83], v[144:147], v[20:23]
s_waitcnt lgkmcnt(10)
v_mfma_f32_16x16x32_bf16 v[24:27], v[84:87], v[148:151], v[24:27]
s_waitcnt lgkmcnt(9)
v_mfma_f32_16x16x32_bf16 v[20:23], v[88:91], v[152:155], v[20:23]
s_waitcnt lgkmcnt(8)
v_mfma_f32_16x16x32_bf16 v[24:27], v[92:95], v[156:159], v[24:27]
s_waitcnt lgkmcnt(7)
v_mfma_f32_16x16x32_bf16 v[20:23], v[96:99], v[160:163], v[20:23]
s_waitcnt lgkmcnt(6)
v_mfma_f32_16x16x32_bf16 v[24:27], v[100:103], v[164:167], v[24:27]
s_waitcnt lgkmcnt(5)
v_mfma_f32_16x16x32_bf16 v[20:23], v[104:107], v[168:171], v[20:23]
s_waitcnt lgkmcnt(4)
v_mfma_f32_16x16x32_bf16 v[24:27], v[108:111], v[172:175], v[24:27]
s_waitcnt lgkmcnt(3)
v_mfma_f32_16x16x32_bf16 v[20:23], v[224:227], v[176:179], v[20:23]
s_waitcnt lgkmcnt(2)
v_mfma_f32_16x16x32_bf16 v[24:27], v[228:231], v[180:183], v[24:27]
s_waitcnt lgkmcnt(1)
v_mfma_f32_16x16x32_bf16 v[20:23], v[232:235], v[184:187], v[20:23]
s_waitcnt lgkmcnt(0)
v_mfma_f32_16x16x32_bf16 v[24:27], v[236:239], v[188:191], v[24:27]
s_mov_b64 exec, 0xffff
s_nop 6
v_add_f32 v20, v20, v24
ds_write_b32 v40, v20 offset:18560
v_add_f32 v21, v21, v25
ds_write_b32 v40, v21 offset:18688
v_add_f32 v22, v22, v26
ds_write_b32 v40, v22 offset:18816
v_add_f32 v23, v23, v27
ds_write_b32 v40, v23 offset:18944
s_mov_b64 exec, -1
s_waitcnt lgkmcnt(0)
s_barrier
ds_read_b64 v[20:21], v41 offset:18560
ds_read_b64 v[22:23], v41 offset:19072
s_waitcnt lgkmcnt(1)
v_cvt_pk_bf16_f32 v20, v20, v21
v_and_b32 v21, 0xffff0000, v20
v_lshlrev_b32 v20, 16, v20
v_mul_f32 v21, 0xbfb8aa3b, v21
v_mul_f32 v20, 0xbfb8aa3b, v20
v_exp_f32 v21, v21
v_exp_f32 v20, v20
s_waitcnt lgkmcnt(0)
v_cvt_pk_bf16_f32 v22, v22, v23
v_add_f32 v21, 1.0, v21
v_add_f32 v20, 1.0, v20
v_rcp_f32 v21, v21
v_rcp_f32 v20, v20
v_and_b32 v23, 0xffff0000, v22
v_lshlrev_b32 v22, 16, v22
v_cvt_pk_bf16_f32 v20, v20, v21
v_and_b32 v21, 0xffff0000, v20
v_lshlrev_b32 v20, 16, v20
v_mul_f32 v21, v21, v23
v_mul_f32 v20, v20, v22
v_cvt_pk_bf16_f32 v36, v20, v21
s_nop 1
v_mov_b32_dpp v32, v36 quad_perm:[0,0,0,0] row_mask:0xf bank_mask:0xf
v_mov_b32_dpp v33, v36 quad_perm:[1,1,1,1] row_mask:0xf bank_mask:0xf
v_mov_b32_dpp v34, v36 quad_perm:[2,2,2,2] row_mask:0xf bank_mask:0xf
v_mov_b32_dpp v35, v36 quad_perm:[3,3,3,3] row_mask:0xf bank_mask:0xf
s_nop 1
v_mfma_f32_16x16x32_bf16 v[64:67], v[32:35], v[192:195], 0
v_mfma_f32_16x16x32_bf16 v[68:71], v[32:35], v[196:199], 0
v_mfma_f32_16x16x32_bf16 v[72:75], v[32:35], v[200:203], 0
v_mfma_f32_16x16x32_bf16 v[76:79], v[32:35], v[204:207], 0
v_mfma_f32_16x16x32_bf16 v[80:83], v[32:35], v[208:211], 0
v_mfma_f32_16x16x32_bf16 v[84:87], v[32:35], v[212:215], 0
v_mfma_f32_16x16x32_bf16 v[88:91], v[32:35], v[216:219], 0
v_mfma_f32_16x16x32_bf16 v[92:95], v[32:35], v[220:223], 0
s_nop 0
v_min_u32 v96, -2, v64
v_min_u32 v97, -2, v68
v_min_u32 v98, -2, v72
v_min_u32 v99, -2, v76
s_nop 0
buffer_store_dwordx4 v[96:99], v42, s[12:15], s59 offen sc1
v_min_u32 v100, -2, v80
v_min_u32 v101, -2, v84
v_min_u32 v102, -2, v88
v_min_u32 v103, -2, v92
buffer_store_dwordx4 v[100:103], v42, s[12:15], s59 offen offset:256 sc1
L_s5:
s_cmp_ge_u32 s79, 256
s_cbranch_scc1 L_fin
v_mov_b32 v48, 0
v_mov_b32 v49, 0
v_mov_b32 v50, 0
v_mov_b32 v51, 0
v_mov_b32 v52, 0
v_mov_b32 v53, 0
v_mov_b32 v54, 0
v_mov_b32 v55, 0
s_mov_b32 exec_lo, -1
s_mov_b32 exec_hi, 0xffffff
s_mov_b32 s66, 0
L_p6:
buffer_load_dwordx4 v[48:51], v45, s[12:15], s63 offen sc1
buffer_load_dwordx4 v[52:55], v45, s[12:15], s63 offen offset:16 sc1
s_waitcnt vmcnt(0)
v_max_u32 v31, v48, v49
v_max3_u32 v31, v31, v50, v51
v_max3_u32 v31, v31, v52, v53
v_max3_u32 v31, v31, v54, v55
v_cmp_eq_u32 vcc, -1, v31
s_cbranch_vccz L_p6_ok
s_mov_b64 exec, vcc
s_add_u32 s66, s66, 1
s_cmp_gt_u32 s66, 400000
s_cbranch_scc1 L_p6_ok
s_sleep 1
s_branch L_p6
L_p6_ok:
s_mov_b64 exec, -1
s_nop 3
v_permlane32_swap_b32 v48, v52
v_permlane32_swap_b32 v49, v53
v_permlane32_swap_b32 v50, v54
v_permlane32_swap_b32 v51, v55
s_nop 1
v_add_f32 v48, v48, v52
v_add_f32 v49, v49, v53
v_add_f32 v50, v50, v54
v_add_f32 v51, v51, v55
s_nop 0
v_add_f32_dpp v48, v48, v48 row_ror:8 row_mask:0xf bank_mask:0x3
v_add_f32_dpp v48, v50, v50 row_ror:8 row_mask:0xf bank_mask:0xc
v_add_f32_dpp v49, v49, v49 row_ror:8 row_mask:0xf bank_mask:0x3
v_add_f32_dpp v49, v51, v51 row_ror:8 row_mask:0xf bank_mask:0xc
v_add_f32_dpp v48, v48, v48 row_half_mirror row_mask:0xf bank_mask:0x5
s_nop 0
v_add_f32_dpp v48, v49, v49 row_half_mirror row_mask:0xf bank_mask:0xa
s_nop 1
v_add_f32_dpp v48, v48, v48 quad_perm:[1,0,3,2] row_mask:0xf bank_mask:0xf
s_nop 1
v_add_f32_dpp v48, v48, v48 quad_perm:[2,3,0,1] row_mask:0xf bank_mask:0xf
v_mov_b32 v49, v48
s_nop 1
v_permlane16_swap_b32 v48, v49
s_nop 1
v_add_f32 v48, v48, v49
v_cvt_pk_bf16_f32 v48, v48, v48
v_lshlrev_b32 v48, 16, v48
v_add_f32 v48, v48, v39
v_cvt_pk_bf16_f32 v48, v48, v48
s_mov_b32 exec_lo, 0x1111
s_mov_b32 exec_hi, 0x1111
buffer_store_short v48, v38, s[16:19], s67 offen
L_fin:
s_cmp_lg_u32 s3, 0
s_cbranch_scc1 L_end
s_cmp_lg_u32 s58, 1
s_cbranch_scc1 L_noep
s_mov_b64 exec, 1
v_mov_b32 v48, s56
v_mov_b32 v49, s57
v_mov_b32 v50, 0
buffer_store_dwordx2 v[48:49], v50, s[12:15], s76 offen sc1
L_noep:
L_end:
s_endpgm
.section .rodata,"a"
.p2align 6
.amdhsa_kernel sequential_preLN__mha_block_cached__glu_gated_glu__decode_kernel
  .amdhsa_next_free_vgpr 256
  .amdhsa_next_free_sgpr 96
  .amdhsa_accum_offset 256
  .amdhsa_group_segment_fixed_size 0
  .amdhsa_kernarg_size 96
  .amdhsa_user_sgpr_count 2
  .amdhsa_user_sgpr_kernarg_segment_ptr 1
  .amdhsa_system_sgpr_workgroup_id_x 1
  .amdhsa_float_denorm_mode_32 3
.end_amdhsa_kernel
```
